```python
import torch

def _softmax(x, axis=-1):
    return torch.softmax(x, dim=axis)
def _gelu(x):
    return torch.nn.functional.gelu(x, approximate="tanh")
def _silu(x):
    return torch.nn.functional.silu(x)
def _sigmoid(x):
    return torch.sigmoid(x)
def _layernorm(x, axis=-1, eps=1e-5):
    m = x.mean(dim=axis, keepdim=True)
    v = x.var(dim=axis, keepdim=True, unbiased=False)
    return (x - m) / torch.sqrt(v + eps)
def _scatter_add(tgt, idx, src, axis=0):
    return tgt.clone().index_add_(axis, idx, src)
def _segment_sum(src, seg, n):
    out = torch.zeros((n,) + src.shape[1:], dtype=src.dtype)
    return out.index_add_(0, seg, src)
def _pad(x, pw):
    flat = tuple(v for pair in reversed(pw) for v in pair)
    return torch.nn.functional.pad(x, flat)

kernel_name = 'parallel_sum__spectral_gfnet__glu_gated_reglu__prompt'

def setup_inputs():

    _w = (lambda a: (lambda t: t.to(torch.bfloat16) if t.is_floating_point() else t)(torch.as_tensor(a)))
    def _A_setup():
        B, S, D = 1, 2048, 448
        Df = D // 2 + 1
        return {
            "x": _w((lambda *s: torch.randn(*s, dtype=torch.bfloat16) * 0.05)(B, S, D)),
            "w_r": _w((lambda *s: torch.randn(*s, dtype=torch.bfloat16) * 0.4)(S, Df) * 0.02),
            "w_i": _w((lambda *s: torch.randn(*s, dtype=torch.bfloat16) * 0.4)(S, Df) * 0.02),
        }
    _A_in = _A_setup()

    def _B_setup():
        B, S, D, F = 1, 2048, 448, 1792
        return {
            "x": _w((lambda *s: torch.randn(*s, dtype=torch.bfloat16) * 0.05)(B, S, D)),
            "W_gate": _w((lambda *s: torch.randn(*s, dtype=torch.bfloat16) * 0.2)(D, F) * (2.0 / D) ** 0.5),
            "W_up": _w((lambda *s: torch.randn(*s, dtype=torch.bfloat16) * 0.2)(D, F) * (2.0 / D) ** 0.5),
            "W_down": _w((lambda *s: torch.randn(*s, dtype=torch.bfloat16) * 0.2)(F, D) * (1.0 / F) ** 0.5),
        }
    _B_in = _B_setup()

    return {
        "A_x": _A_in["x"],
        "A_w_r": _A_in["w_r"],
        "A_w_i": _A_in["w_i"],
        "B_x": _B_in["x"],
        "B_W_gate": _B_in["W_gate"],
        "B_W_up": _B_in["W_up"],
        "B_W_down": _B_in["W_down"],
    }

def reference(A_x, A_w_r, A_w_i, B_x, B_W_gate, B_W_up, B_W_down):
    def _A_ref(x, w_r, w_i):
        B, S, D = x.shape
        X = (lambda x, axes=(-2,-1): torch.fft.rfft2(x.float(), dim=axes))(x, axes=(-2, -1))
        W = w_r + 1j * w_i
        X = X * W
        y = (lambda x, s, axes=(-2,-1): torch.fft.irfft2(x, s=s, dim=axes).to(torch.bfloat16))(X, (S, D), axes=(-2, -1))
        return y

    def _B_ref(x, W_gate, W_up, W_down):
        gate = torch.einsum("bsd,df->bsf", x, W_gate)
        up = torch.einsum("bsd,df->bsf", x, W_up)
        gate = gate * (lambda x, dt: x.to(dt))(gate > 0, gate.dtype)
        h = gate * up
        return torch.einsum("bsf,fd->bsd", h, W_down)

    x = A_x
    xn = _layernorm(x, axis=-1)
    return x + _A_ref(xn, A_w_r, A_w_i) + _B_ref(xn, B_W_gate, B_W_up, B_W_down)
```

```asm
; @launch grid=(256,1,1) block=(512,1,1) lds=163840
.amdgcn_target "amdgcn-amd-amdhsa--gfx950"
.text
.globl parallel_sum__spectral_gfnet__glu_gated_reglu__prompt_kernel
.type parallel_sum__spectral_gfnet__glu_gated_reglu__prompt_kernel,@function
.p2align 8
parallel_sum__spectral_gfnet__glu_gated_reglu__prompt_kernel:
  s_cmp_ge_u32 s2, 256
  s_cbranch_scc1 f_end
  s_load_dwordx16 s[4:19], s[0:1], 0
  s_load_dwordx4 s[20:23], s[0:1], 64
  s_getpc_b64 s[86:87]
pc0:
  v_lshlrev_b32 v252, 7, v0
  v_min_u32 v252, f_end-pc0, v252
  v_mov_b32 v253, s87
  v_add_co_u32 v252, vcc, s86, v252
  v_addc_co_u32 v253, vcc, 0, v253, vcc
  global_load_dword v255, v[252:253], off
  v_lshrrev_b32 v1, 6, v0
  v_and_b32 v0, 63, v0
  v_readfirstlane_b32 s3, v1
  v_lshrrev_b32 v3, 3, v0
  v_and_b32 v4, 7, v0
  v_lshrrev_b32 v5, 4, v0
  v_xor_b32 v4, v4, v5
  v_mul_u32_u24 v12, 896, v3
  v_lshl_add_u32 v12, v4, 4, v12
  v_xor_b32 v13, 64, v12
  v_add_u32 v13, 7168, v13
  s_and_b32 s56, s2, 7
  s_lshr_b32 s57, s2, 3
  s_add_u32 s57, s57, 28
  s_and_b32 s57, s57, 31
  s_and_b32 s64, s3, 3
  s_cmp_ge_u32 s57, 28
  s_cbranch_scc1 dft_wg
  s_lshr_b32 s65, s56, 1
  s_mul_i32 s65, s65, 28
  s_add_u32 s65, s65, s57
  s_lshr_b32 s58, s65, 3
  s_and_b32 s59, s65, 7
  s_and_b32 s65, s56, 1
  s_lshl_b32 s65, s65, 3
  s_add_u32 s59, s59, s65
  s_mul_i32 s60, s57, 37
  s_lshr_b32 s60, s60, 8
  s_mul_i32 s61, s60, 7
  s_sub_u32 s61, s57, s61
  s_lshl_b32 s65, s56, 2
  s_add_u32 s60, s60, s65
  s_mul_i32 s62, s56, 28
  s_add_u32 s62, s62, s57
  s_mov_b32 s63, s62
  v_lshrrev_b32 v5, 4, v0
  v_lshlrev_b32 v6, 2, v5
  v_and_b32 v7, 15, v0
  v_xor_b32 v6, v6, v7
  v_mul_u32_u24 v11, 3584, v5
  v_lshl_add_u32 v11, v6, 4, v11
  s_lshl_b32 s69, s58, 8
  s_sub_u32 s70, 1605632, s69
  s_lshl_b32 s65, s59, 3
  s_bfe_u32 s66, s3, 65537
  s_lshl_b32 s66, s66, 2
  s_add_u32 s66, s66, s65
  s_lshr_b32 s67, s3, 2
  s_add_u32 s66, s66, s67
  s_and_b32 s67, s3, 1
  s_lshl_b32 s67, s67, 1
  s_add_u32 s66, s66, s67
  s_mul_i32 s66, s66, 14336
  s_mul_i32 s68, s3, 14336
  s_lshl_b32 s71, s3, 10
  s_lshl_b32 s72, s3, 11
  s_add_u32 s78, s59, s58
  s_mul_i32 s67, s78, 37
  s_lshr_b32 s67, s67, 8
  s_mul_i32 s67, s67, 7
  s_sub_u32 s78, s78, s67
  s_mul_i32 s78, s78, 0
  s_add_u32 s66, s66, s78
  s_mul_i32 s67, s78, 1792
  s_add_u32 s68, s68, s67
  s_waitcnt lgkmcnt(0)
  s_mov_b32 s24, s4
  s_mov_b32 s25, s5
  s_mov_b32 s26, 1835008
  s_mov_b32 s27, 0x00020000
  s_add_u32 m0, s72, 0
  s_nop 0
  buffer_load_dwordx4 v12, s[24:27], s66 offen lds
  s_add_u32 m0, s72, 1024
  s_nop 0
  buffer_load_dwordx4 v13, s[24:27], s66 offen lds
  s_add_u32 s28, s12, s69
  s_addc_u32 s29, s13, 0
  s_mov_b32 s30, s70
  s_mov_b32 s31, 0x00020000
  s_add_u32 s32, s14, s69
  s_addc_u32 s33, s15, 0
  s_mov_b32 s34, s70
  s_mov_b32 s35, 0x00020000
  s_add_u32 m0, s71, 16384
  s_nop 0
  buffer_load_dwordx4 v11, s[28:31], s68 offen lds
  s_add_u32 m0, s71, 24576
  s_nop 0
  buffer_load_dwordx4 v11, s[32:35], s68 offen lds
  s_add_u32 s68, s68, 114688
  s_add_u32 m0, s71, 32768
  s_nop 0
  buffer_load_dwordx4 v11, s[28:31], s68 offen lds
  s_add_u32 m0, s71, 40960
  s_nop 0
  buffer_load_dwordx4 v11, s[32:35], s68 offen lds
  s_mov_b32 s79, 20000
  s_cmp_ge_u32 s3, 4
  s_cbranch_scc1 gu_helper
  s_mov_b32 s40, s20
  s_mov_b32 s41, s21
  s_mov_b32 s42, 256
  s_mov_b32 s43, 0x00020000
  v_mov_b32 v30, 1
  v_lshlrev_b32 v31, 20, v0
  s_mov_b32 s28, s22
  s_mov_b32 s29, s23
  s_mov_b32 s30, 7405568
  s_mov_b32 s31, 0x00020000
  s_mul_i32 s65, s59, 452
  s_lshl_b32 s66, s58, 3
  s_add_u32 s65, s65, s66
  s_lshl_b32 s66, s64, 1
  s_add_u32 s65, s65, s66
  s_lshl_b32 s65, s65, 10
  s_add_u32 s66, s65, 115712
  s_add_u32 s67, s65, 231424
  s_add_u32 s68, s65, 347136
  s_lshl_b32 s71, s58, 2
  s_add_u32 s71, s71, s64
  s_mul_i32 s72, s71, 37
  s_lshr_b32 s72, s72, 8
  s_mul_i32 s73, s72, 7
  s_sub_u32 s71, s71, s73
  s_lshl_b32 s71, s71, 2
  s_lshl_b32 s73, s59, 3
  s_add_u32 s72, s72, s73
  s_lshl_b32 s72, s72, 7
  s_add_u32 s71, s71, s72
  s_add_u32 s71, s71, 8192
  v_lshlrev_b32 v1, 4, v0
  s_mov_b32 s36, s16
  s_mov_b32 s37, s17
  s_mov_b32 s38, 1605632
  s_mov_b32 s39, 0x00020000
  s_add_u32 s52, s22, 13165312
  s_addc_u32 s53, s23, 0
  s_mov_b32 s54, 16384
  s_mov_b32 s55, 0x00020000
  v_lshrrev_b32 v5, 3, v0
  v_bfe_u32 v6, v0, 4, 1
  v_lshlrev_b32 v6, 2, v6
  v_and_b32 v29, 7, v0
  v_xor_b32 v6, v6, v29
  v_mul_u32_u24 v29, 896, v5
  v_lshl_add_u32 v29, v6, 4, v29
  v_and_b32 v14, 31, v0
  v_lshrrev_b32 v3, 5, v0
  v_bfe_u32 v9, v0, 1, 3
  v_xor_b32 v9, v9, v3
  v_lshlrev_b32 v9, 4, v9
  v_lshl_add_u32 v8, v14, 7, v9
  v_lshlrev_b32 v14, 2, v14
  v_bfe_u32 v9, v0, 2, 2
  v_lshl_add_u32 v10, v3, 3, v9
  v_lshlrev_b32 v2, 8, v10
  v_xor_b32 v9, s64, v9
  v_lshl_add_u32 v2, v9, 6, v2
  v_bfe_u32 v9, v0, 4, 1
  v_lshl_add_u32 v2, v9, 5, v2
  v_and_b32 v9, 3, v0
  v_lshl_add_u32 v2, v9, 3, v2
  v_add_u32 v3, 0x10000, v2
  v_add_u32 v4, 0x20000, v2
  v_mov_b32 v7, 155776
  v_mov_b32 v16, 0
  v_mov_b32 v17, 0
  v_mov_b32 v18, 0
  v_mov_b32 v19, 0
  s_mov_b32 s85, 0xffff0000
  s_lshl_b32 s70, s59, 9
  v_mov_b32 v84, 0
  v_mov_b32 v85, 0
  v_mov_b32 v86, 0
  v_mov_b32 v87, 0
  v_mov_b32 v88, 0
  v_mov_b32 v89, 0
  v_mov_b32 v90, 0
  v_mov_b32 v91, 0
  v_mov_b32 v92, 0
  v_mov_b32 v93, 0
  v_mov_b32 v94, 0
  v_mov_b32 v95, 0
  v_mov_b32 v96, 0
  v_mov_b32 v97, 0
  v_mov_b32 v98, 0
  v_mov_b32 v99, 0
  v_mov_b32 v100, 0
  v_mov_b32 v101, 0
  v_mov_b32 v102, 0
  v_mov_b32 v103, 0
  v_mov_b32 v104, 0
  v_mov_b32 v105, 0
  v_mov_b32 v106, 0
  v_mov_b32 v107, 0
  s_add_u32 s32, s22, 7405568
  s_addc_u32 s33, s23, 0
  s_mov_b32 s34, 5759744
  s_mov_b32 s35, 0x00020000
  s_mov_b32 s44, s18
  s_mov_b32 s45, s19
  s_mov_b32 s46, 1835008
  s_mov_b32 s47, 0x00020000
  s_cmp_eq_u32 s64, 3
  s_cselect_b32 s74, 8192, 0x40000000
  v_mul_u32_u24 v9, 236544, v0
  v_add_u32 v9, 1949696, v9
  v_mul_u32_u24 v11, 121856, v0
  v_lshlrev_b32 v10, 17, v0
  s_mov_b64 exec, 0xffff
  buffer_load_dword v124, v9, s[32:35], s74 offen
  buffer_load_dword v127, v11, s[32:35], s74 offen
  buffer_load_dword v125, v10, s[44:47], s74 offen
  buffer_load_dword v126, v10, s[36:39], s74 offen
  s_cmp_eq_u32 s64, 2
  s_cselect_b32 s74, 114688, 0x40000000
  v_mul_u32_u24 v9, 462848, v0
  buffer_load_dword v124, v9, s[28:31], s74 offen
  s_mov_b32 s32, s12
  s_mov_b32 s33, s13
  s_mov_b32 s34, 1605632
  s_mov_b32 s35, 0x00020000
  s_mov_b32 s44, s14
  s_mov_b32 s45, s15
  s_mov_b32 s46, 1605632
  s_mov_b32 s47, 0x00020000
  buffer_load_dword v125, v10, s[32:35], s74 offen
  buffer_load_dword v126, v10, s[44:47], s74 offen
  s_mov_b64 exec, -1
  s_mov_b32 s32, s6
  s_mov_b32 s33, s7
  s_mov_b32 s34, 921600
  s_mov_b32 s35, 0x00020000
  s_mov_b32 s44, s8
  s_mov_b32 s45, s9
  s_mov_b32 s46, 921600
  s_mov_b32 s47, 0x00020000
  s_add_u32 s48, s22, 9355264
  s_addc_u32 s49, s23, 0
  s_mov_b32 s50, 1909248
  s_mov_b32 s51, 0x00020000
  s_mul_i32 s74, s64, 224
  s_add_u32 s74, s74, s62
  s_lshr_b32 s75, s74, 6
  s_lshl_b32 s75, s75, 8
  s_bfe_u32 s76, s74, 131076
  s_lshl_b32 s76, s76, 4
  s_add_u32 s75, s75, s76
  s_bfe_u32 s76, s74, 65539
  s_add_u32 s75, s75, s76
  s_mul_i32 s75, s75, 450
  s_and_b32 s75, s75, -4
  s_and_b32 s77, s74, 7
  s_lshl_b32 s78, s77, 6
  s_add_u32 s75, s75, s78
  v_and_b32 v9, 7, v0
  v_lshrrev_b32 v10, 3, v0
  v_lshl_add_u32 v12, v9, 3, v10
  v_lshlrev_b32 v12, 2, v12
  v_mul_u32_u24 v11, 900, v10
  v_lshl_add_u32 v11, v9, 3, v11
  v_mul_u32_u24 v15, 33792, v10
  v_lshl_add_u32 v15, v9, 4, v15
  s_lshl_b32 s77, s77, 5
  s_add_u32 s77, s77, 1
  s_sub_u32 s77, s77, s76
  s_mul_i32 s77, s77, 8448
  s_and_b32 s76, s74, 15
  s_lshl_b32 s76, s76, 9
  s_add_u32 s76, s76, 57344
  s_lshr_b32 s78, s74, 3
  s_lshl_b32 s78, s78, 7
  s_cmp_lt_u32 s74, 512
  s_cselect_b32 s74, s78, 0x40000000
  s_cselect_b32 s76, s76, 0x40000000
  s_add_u32 s74, s74, s77
  s_mov_b32 s82, 0x05040100
  s_mov_b32 s83, 0x07060302
  v_lshlrev_b32 v13, 7, v0
  v_cmp_gt_u32 vcc, 4, v0
  s_nop 1
  v_cndmask_b32 v13, v31, v13, vcc
  s_and_b32 s77, s63, 63
  s_lshl_b32 s77, s77, 7
  v_mov_b32 v9, s77
  s_and_b32 s77, s63, 3
  s_lshl_b32 s77, s77, 7
  s_add_u32 s77, s77, 57344
  s_lshr_b32 s78, s63, 5
  s_lshl_b32 s78, s78, 9
  s_add_u32 s78, s78, s77
  v_writelane_b32 v9, s78, 1
  s_add_u32 s78, s63, 1
  s_lshr_b32 s78, s78, 5
  s_lshl_b32 s78, s78, 9
  s_add_u32 s78, s78, s77
  s_add_u32 s78, s78, 4096
  v_writelane_b32 v9, s78, 2
  s_lshl_b32 s78, s64, 28
  v_xor_b32 v5, 0, v8
  v_xor_b32 v6, 32, v8
  s_waitcnt lgkmcnt(0) vmcnt(9)
  s_barrier
  ds_read_b64_tr_b16 v[32:33], v2 offset:16384
  ds_read_b64_tr_b16 v[34:35], v2 offset:17408
  ds_read_b128 v[48:51], v5 offset:0
  ds_read_b64_tr_b16 v[36:37], v2 offset:24576
  ds_read_b64_tr_b16 v[38:39], v2 offset:25600
  ds_read_b128 v[52:55], v5 offset:4096
  ds_read_b128 v[56:59], v5 offset:8192
  ds_read_b128 v[60:63], v5 offset:12288
  s_waitcnt lgkmcnt(0)
  v_mfma_f32_32x32x16_bf16 v[128:143], v[32:35], v[48:51], 0
  ds_read_b64_tr_b16 v[40:41], v2 offset:20480
  ds_read_b64_tr_b16 v[42:43], v2 offset:21504
  v_lshlrev_b32 v20, 16, v32
  v_and_b32 v21, s85, v32
  v_add_f32 v16, v16, v20
  v_mfma_f32_32x32x16_bf16 v[192:207], v[36:39], v[48:51], 0
  ds_read_b128 v[64:67], v6 offset:0
  ds_read_b64_tr_b16 v[44:45], v2 offset:28672
  v_add_f32 v17, v17, v21
  v_lshlrev_b32 v22, 16, v33
  v_and_b32 v23, s85, v33
  v_mfma_f32_32x32x16_bf16 v[144:159], v[32:35], v[52:55], 0
  ds_read_b64_tr_b16 v[46:47], v2 offset:29696
  ds_read_b128 v[68:71], v6 offset:4096
  v_add_f32 v16, v16, v22
  v_add_f32 v17, v17, v23
  v_lshlrev_b32 v24, 16, v34
  buffer_load_dwordx2 v[108:109], v11, s[32:35], s75 offen
  buffer_load_dwordx2 v[116:117], v11, s[44:47], s75 offen
  s_add_u32 s75, s75, 28800
  v_mfma_f32_32x32x16_bf16 v[208:223], v[36:39], v[52:55], 0
  ds_read_b128 v[72:75], v6 offset:8192
  ds_read_b128 v[76:79], v6 offset:12288
  v_and_b32 v25, s85, v34
  v_add_f32 v16, v16, v24
  v_add_f32 v17, v17, v25
  buffer_load_dwordx2 v[110:111], v11, s[32:35], s75 offen
  buffer_load_dwordx2 v[118:119], v11, s[44:47], s75 offen
  s_add_u32 s75, s75, 28800
  v_mfma_f32_32x32x16_bf16 v[160:175], v[32:35], v[56:59], 0
  v_lshlrev_b32 v26, 16, v35
  v_and_b32 v27, s85, v35
  v_add_f32 v16, v16, v26
  v_add_f32 v17, v17, v27
  v_xor_b32 v5, 64, v8
  v_lshlrev_b32 v20, 16, v36
  v_mfma_f32_32x32x16_bf16 v[224:239], v[36:39], v[56:59], 0
  v_and_b32 v21, s85, v36
  v_add_f32 v18, v18, v20
  v_add_f32 v19, v19, v21
  v_lshlrev_b32 v22, 16, v37
  v_and_b32 v23, s85, v37
  v_add_f32 v18, v18, v22
  v_mfma_f32_32x32x16_bf16 v[176:191], v[32:35], v[60:63], 0
  v_add_f32 v19, v19, v23
  v_lshlrev_b32 v24, 16, v38
  v_and_b32 v25, s85, v38
  v_add_f32 v18, v18, v24
  v_add_f32 v19, v19, v25
  v_lshlrev_b32 v26, 16, v39
  v_mfma_f32_32x32x16_bf16 v[240:255], v[36:39], v[60:63], 0
  v_and_b32 v27, s85, v39
  v_add_f32 v18, v18, v26
  v_add_f32 v19, v19, v27
  s_waitcnt lgkmcnt(0) vmcnt(11)
  v_mfma_f32_32x32x16_bf16 v[128:143], v[40:43], v[64:67], v[128:143]
  s_barrier
  ds_read_b64_tr_b16 v[32:33], v2 offset:32768
  ds_read_b64_tr_b16 v[34:35], v2 offset:33792
  v_lshlrev_b32 v20, 16, v40
  v_and_b32 v21, s85, v40
  v_add_f32 v16, v16, v20
  v_mfma_f32_32x32x16_bf16 v[192:207], v[44:47], v[64:67], v[192:207]
  ds_read_b128 v[48:51], v5 offset:0
  ds_read_b64_tr_b16 v[36:37], v2 offset:40960
  v_add_f32 v17, v17, v21
  v_lshlrev_b32 v22, 16, v41
  v_and_b32 v23, s85, v41
  v_mfma_f32_32x32x16_bf16 v[144:159], v[40:43], v[68:71], v[144:159]
  ds_read_b64_tr_b16 v[38:39], v2 offset:41984
  ds_read_b128 v[52:55], v5 offset:4096
  v_add_f32 v16, v16, v22
  v_add_f32 v17, v17, v23
  v_lshlrev_b32 v24, 16, v42
  buffer_load_dwordx2 v[112:113], v11, s[32:35], s75 offen
  buffer_load_dwordx2 v[120:121], v11, s[44:47], s75 offen
  s_add_u32 s75, s75, 28800
  v_mfma_f32_32x32x16_bf16 v[208:223], v[44:47], v[68:71], v[208:223]
  ds_read_b128 v[56:59], v5 offset:8192
  ds_read_b128 v[60:63], v5 offset:12288
  v_and_b32 v25, s85, v42
  v_add_f32 v16, v16, v24
  v_add_f32 v17, v17, v25
  buffer_load_dwordx2 v[114:115], v11, s[32:35], s75 offen
  buffer_load_dwordx2 v[122:123], v11, s[44:47], s75 offen
  s_add_u32 s44, s22, 13181696
  s_addc_u32 s45, s23, 0
  s_mov_b32 s46, 65536
  s_mov_b32 s47, 0x00020000
  v_mfma_f32_32x32x16_bf16 v[160:175], v[40:43], v[72:75], v[160:175]
  v_lshlrev_b32 v26, 16, v43
  v_and_b32 v27, s85, v43
  v_add_f32 v16, v16, v26
  v_add_f32 v17, v17, v27
  v_xor_b32 v6, 96, v8
  v_lshlrev_b32 v20, 16, v44
  v_mfma_f32_32x32x16_bf16 v[224:239], v[44:47], v[72:75], v[224:239]
  v_and_b32 v21, s85, v44
  v_add_f32 v18, v18, v20
  v_add_f32 v19, v19, v21
  v_lshlrev_b32 v22, 16, v45
  v_and_b32 v23, s85, v45
  v_add_f32 v18, v18, v22
  v_mfma_f32_32x32x16_bf16 v[176:191], v[40:43], v[76:79], v[176:191]
  v_add_f32 v19, v19, v23
  v_lshlrev_b32 v24, 16, v46
  v_and_b32 v25, s85, v46
  v_add_f32 v18, v18, v24
  v_add_f32 v19, v19, v25
  v_lshlrev_b32 v26, 16, v47
  v_mfma_f32_32x32x16_bf16 v[240:255], v[44:47], v[76:79], v[240:255]
  v_and_b32 v27, s85, v47
  v_add_f32 v18, v18, v26
  v_add_f32 v19, v19, v27
  s_waitcnt lgkmcnt(0)
  v_mfma_f32_32x32x16_bf16 v[128:143], v[32:35], v[48:51], v[128:143]
  ds_read_b64_tr_b16 v[40:41], v2 offset:36864
  ds_read_b64_tr_b16 v[42:43], v2 offset:37888
  v_lshlrev_b32 v20, 16, v32
  v_and_b32 v21, s85, v32
  v_add_f32 v16, v16, v20
  v_mfma_f32_32x32x16_bf16 v[192:207], v[36:39], v[48:51], v[192:207]
  ds_read_b128 v[64:67], v6 offset:0
  ds_read_b64_tr_b16 v[44:45], v2 offset:45056
  v_add_f32 v17, v17, v21
  v_lshlrev_b32 v22, 16, v33
  v_and_b32 v23, s85, v33
  v_mfma_f32_32x32x16_bf16 v[144:159], v[32:35], v[52:55], v[144:159]
  ds_read_b64_tr_b16 v[46:47], v2 offset:46080
  ds_read_b128 v[68:71], v6 offset:4096
  v_add_f32 v16, v16, v22
  v_add_f32 v17, v17, v23
  v_lshlrev_b32 v24, 16, v34
  v_mfma_f32_32x32x16_bf16 v[208:223], v[36:39], v[52:55], v[208:223]
  ds_read_b128 v[72:75], v6 offset:8192
  ds_read_b128 v[76:79], v6 offset:12288
  v_and_b32 v25, s85, v34
  v_add_f32 v16, v16, v24
  v_add_f32 v17, v17, v25
  v_mfma_f32_32x32x16_bf16 v[160:175], v[32:35], v[56:59], v[160:175]
  v_lshlrev_b32 v26, 16, v35
  v_and_b32 v27, s85, v35
  v_add_f32 v16, v16, v26
  v_add_f32 v17, v17, v27
  v_xor_b32 v5, 49152, v8
  v_lshlrev_b32 v20, 16, v36
  v_mfma_f32_32x32x16_bf16 v[224:239], v[36:39], v[56:59], v[224:239]
  v_and_b32 v21, s85, v36
  v_add_f32 v18, v18, v20
  v_add_f32 v19, v19, v21
  v_lshlrev_b32 v22, 16, v37
  v_and_b32 v23, s85, v37
  v_add_f32 v18, v18, v22
  v_mfma_f32_32x32x16_bf16 v[176:191], v[32:35], v[60:63], v[176:191]
  v_add_f32 v19, v19, v23
  v_lshlrev_b32 v24, 16, v38
  v_and_b32 v25, s85, v38
  v_add_f32 v18, v18, v24
  v_add_f32 v19, v19, v25
  v_lshlrev_b32 v26, 16, v39
  v_mfma_f32_32x32x16_bf16 v[240:255], v[36:39], v[60:63], v[240:255]
  v_and_b32 v27, s85, v39
  v_add_f32 v18, v18, v26
  v_add_f32 v19, v19, v27
  s_waitcnt lgkmcnt(0)
  v_mfma_f32_32x32x16_bf16 v[128:143], v[40:43], v[64:67], v[128:143]
  s_barrier
  ds_read_b64_tr_b16 v[32:33], v3 offset:0
  ds_read_b64_tr_b16 v[34:35], v3 offset:1024
  v_lshlrev_b32 v20, 16, v40
  v_and_b32 v21, s85, v40
  v_add_f32 v16, v16, v20
  v_mfma_f32_32x32x16_bf16 v[192:207], v[44:47], v[64:67], v[192:207]
  ds_read_b128 v[48:51], v5 offset:0
  ds_read_b64_tr_b16 v[36:37], v3 offset:8192
  v_add_f32 v17, v17, v21
  v_lshlrev_b32 v22, 16, v41
  v_and_b32 v23, s85, v41
  v_mfma_f32_32x32x16_bf16 v[144:159], v[40:43], v[68:71], v[144:159]
  ds_read_b64_tr_b16 v[38:39], v3 offset:9216
  ds_read_b128 v[52:55], v5 offset:4096
  v_add_f32 v16, v16, v22
  v_add_f32 v17, v17, v23
  v_lshlrev_b32 v24, 16, v42
  v_mfma_f32_32x32x16_bf16 v[208:223], v[44:47], v[68:71], v[208:223]
  ds_read_b128 v[56:59], v5 offset:8192
  ds_read_b128 v[60:63], v5 offset:12288
  v_and_b32 v25, s85, v42
  v_add_f32 v16, v16, v24
  v_add_f32 v17, v17, v25
  v_mfma_f32_32x32x16_bf16 v[160:175], v[40:43], v[72:75], v[160:175]
  v_lshlrev_b32 v26, 16, v43
  v_and_b32 v27, s85, v43
  v_add_f32 v16, v16, v26
  v_add_f32 v17, v17, v27
  v_xor_b32 v6, 49184, v8
  v_lshlrev_b32 v20, 16, v44
  v_mfma_f32_32x32x16_bf16 v[224:239], v[44:47], v[72:75], v[224:239]
  v_and_b32 v21, s85, v44
  v_add_f32 v18, v18, v20
  v_add_f32 v19, v19, v21
  v_lshlrev_b32 v22, 16, v45
  v_and_b32 v23, s85, v45
  v_add_f32 v18, v18, v22
  v_mfma_f32_32x32x16_bf16 v[176:191], v[40:43], v[76:79], v[176:191]
  v_add_f32 v19, v19, v23
  v_lshlrev_b32 v24, 16, v46
  v_and_b32 v25, s85, v46
  v_add_f32 v18, v18, v24
  v_add_f32 v19, v19, v25
  v_lshlrev_b32 v26, 16, v47
  v_mfma_f32_32x32x16_bf16 v[240:255], v[44:47], v[76:79], v[240:255]
  v_and_b32 v27, s85, v47
  v_add_f32 v18, v18, v26
  v_add_f32 v19, v19, v27
  s_waitcnt lgkmcnt(0)
  v_mfma_f32_32x32x16_bf16 v[128:143], v[32:35], v[48:51], v[128:143]
  ds_read_b64_tr_b16 v[40:41], v3 offset:4096
  ds_read_b64_tr_b16 v[42:43], v3 offset:5120
  v_lshlrev_b32 v20, 16, v32
  v_and_b32 v21, s85, v32
  v_add_f32 v16, v16, v20
  v_mfma_f32_32x32x16_bf16 v[192:207], v[36:39], v[48:51], v[192:207]
  ds_read_b128 v[64:67], v6 offset:0
  ds_read_b64_tr_b16 v[44:45], v3 offset:12288
  v_add_f32 v17, v17, v21
  v_lshlrev_b32 v22, 16, v33
  v_and_b32 v23, s85, v33
  v_mfma_f32_32x32x16_bf16 v[144:159], v[32:35], v[52:55], v[144:159]
  ds_read_b64_tr_b16 v[46:47], v3 offset:13312
  ds_read_b128 v[68:71], v6 offset:4096
  v_add_f32 v16, v16, v22
  v_add_f32 v17, v17, v23
  v_lshlrev_b32 v24, 16, v34
  v_mfma_f32_32x32x16_bf16 v[208:223], v[36:39], v[52:55], v[208:223]
  ds_read_b128 v[72:75], v6 offset:8192
  ds_read_b128 v[76:79], v6 offset:12288
  v_and_b32 v25, s85, v34
  v_add_f32 v16, v16, v24
  v_add_f32 v17, v17, v25
  v_mfma_f32_32x32x16_bf16 v[160:175], v[32:35], v[56:59], v[160:175]
  v_lshlrev_b32 v26, 16, v35
  v_and_b32 v27, s85, v35
  v_add_f32 v16, v16, v26
  v_add_f32 v17, v17, v27
  v_xor_b32 v5, 49216, v8
  v_lshlrev_b32 v20, 16, v36
  v_mfma_f32_32x32x16_bf16 v[224:239], v[36:39], v[56:59], v[224:239]
  v_and_b32 v21, s85, v36
  v_add_f32 v18, v18, v20
  v_add_f32 v19, v19, v21
  v_lshlrev_b32 v22, 16, v37
  v_and_b32 v23, s85, v37
  v_add_f32 v18, v18, v22
  v_mfma_f32_32x32x16_bf16 v[176:191], v[32:35], v[60:63], v[176:191]
  v_add_f32 v19, v19, v23
  v_lshlrev_b32 v24, 16, v38
  v_and_b32 v25, s85, v38
  v_add_f32 v18, v18, v24
  v_add_f32 v19, v19, v25
  v_lshlrev_b32 v26, 16, v39
  v_mfma_f32_32x32x16_bf16 v[240:255], v[36:39], v[60:63], v[240:255]
  v_and_b32 v27, s85, v39
  v_add_f32 v18, v18, v26
  v_add_f32 v19, v19, v27
  s_waitcnt lgkmcnt(0)
  v_mfma_f32_32x32x16_bf16 v[128:143], v[40:43], v[64:67], v[128:143]
  s_barrier
  ds_read_b64_tr_b16 v[32:33], v3 offset:16384
  ds_read_b64_tr_b16 v[34:35], v3 offset:17408
  v_lshlrev_b32 v20, 16, v40
  v_and_b32 v21, s85, v40
  v_add_f32 v16, v16, v20
  v_mfma_f32_32x32x16_bf16 v[192:207], v[44:47], v[64:67], v[192:207]
  ds_read_b128 v[48:51], v5 offset:0
  ds_read_b64_tr_b16 v[36:37], v3 offset:24576
  v_add_f32 v17, v17, v21
  v_lshlrev_b32 v22, 16, v41
  v_and_b32 v23, s85, v41
  v_mfma_f32_32x32x16_bf16 v[144:159], v[40:43], v[68:71], v[144:159]
  ds_read_b64_tr_b16 v[38:39], v3 offset:25600
  ds_read_b128 v[52:55], v5 offset:4096
  v_add_f32 v16, v16, v22
  v_add_f32 v17, v17, v23
  v_lshlrev_b32 v24, 16, v42
  buffer_load_dword v28, v31, s[40:43], 0 offen
  v_mfma_f32_32x32x16_bf16 v[208:223], v[44:47], v[68:71], v[208:223]
  ds_read_b128 v[56:59], v5 offset:8192
  ds_read_b128 v[60:63], v5 offset:12288
  v_and_b32 v25, s85, v42
  v_add_f32 v16, v16, v24
  v_add_f32 v17, v17, v25
  s_waitcnt vmcnt(1)
  ds_bpermute_b32 v108, v12, v108
  ds_bpermute_b32 v109, v12, v109
  ds_bpermute_b32 v110, v12, v110
  ds_bpermute_b32 v111, v12, v111
  ds_bpermute_b32 v112, v12, v112
  ds_bpermute_b32 v113, v12, v113
  ds_bpermute_b32 v114, v12, v114
  ds_bpermute_b32 v115, v12, v115
  v_mfma_f32_32x32x16_bf16 v[160:175], v[40:43], v[72:75], v[160:175]
  v_lshlrev_b32 v26, 16, v43
  v_and_b32 v27, s85, v43
  v_add_f32 v16, v16, v26
  v_add_f32 v17, v17, v27
  v_xor_b32 v6, 49248, v8
  v_lshlrev_b32 v20, 16, v44
  v_mfma_f32_32x32x16_bf16 v[224:239], v[44:47], v[72:75], v[224:239]
  v_and_b32 v21, s85, v44
  v_add_f32 v18, v18, v20
  v_add_f32 v19, v19, v21
  v_lshlrev_b32 v22, 16, v45
  v_and_b32 v23, s85, v45
  v_add_f32 v18, v18, v22
  v_mfma_f32_32x32x16_bf16 v[176:191], v[40:43], v[76:79], v[176:191]
  v_add_f32 v19, v19, v23
  v_lshlrev_b32 v24, 16, v46
  v_and_b32 v25, s85, v46
  v_add_f32 v18, v18, v24
  v_add_f32 v19, v19, v25
  v_lshlrev_b32 v26, 16, v47
  v_mfma_f32_32x32x16_bf16 v[240:255], v[44:47], v[76:79], v[240:255]
  v_and_b32 v27, s85, v47
  v_add_f32 v18, v18, v26
  v_add_f32 v19, v19, v27
  s_waitcnt lgkmcnt(0)
  v_mfma_f32_32x32x16_bf16 v[128:143], v[32:35], v[48:51], v[128:143]
  ds_read_b64_tr_b16 v[40:41], v3 offset:20480
  ds_read_b64_tr_b16 v[42:43], v3 offset:21504
  v_lshlrev_b32 v20, 16, v32
  v_and_b32 v21, s85, v32
  v_add_f32 v16, v16, v20
  v_mfma_f32_32x32x16_bf16 v[192:207], v[36:39], v[48:51], v[192:207]
  ds_read_b128 v[64:67], v6 offset:0
  ds_read_b64_tr_b16 v[44:45], v3 offset:28672
  v_add_f32 v17, v17, v21
  v_lshlrev_b32 v22, 16, v33
  v_and_b32 v23, s85, v33
  v_mfma_f32_32x32x16_bf16 v[144:159], v[32:35], v[52:55], v[144:159]
  ds_read_b64_tr_b16 v[46:47], v3 offset:29696
  ds_read_b128 v[68:71], v6 offset:4096
  v_add_f32 v16, v16, v22
  v_add_f32 v17, v17, v23
  v_lshlrev_b32 v24, 16, v34
  ds_bpermute_b32 v116, v12, v116
  ds_bpermute_b32 v117, v12, v117
  ds_bpermute_b32 v118, v12, v118
  ds_bpermute_b32 v119, v12, v119
  ds_bpermute_b32 v120, v12, v120
  ds_bpermute_b32 v121, v12, v121
  ds_bpermute_b32 v122, v12, v122
  ds_bpermute_b32 v123, v12, v123
  v_mfma_f32_32x32x16_bf16 v[208:223], v[36:39], v[52:55], v[208:223]
  ds_read_b128 v[72:75], v6 offset:8192
  ds_read_b128 v[76:79], v6 offset:12288
  v_and_b32 v25, s85, v34
  v_add_f32 v16, v16, v24
  v_add_f32 v17, v17, v25
  v_mfma_f32_32x32x16_bf16 v[160:175], v[32:35], v[56:59], v[160:175]
  v_lshlrev_b32 v26, 16, v35
  v_and_b32 v27, s85, v35
  v_add_f32 v16, v16, v26
  v_add_f32 v17, v17, v27
  v_xor_b32 v5, 98304, v8
  v_lshlrev_b32 v20, 16, v36
  v_mfma_f32_32x32x16_bf16 v[224:239], v[36:39], v[56:59], v[224:239]
  v_and_b32 v21, s85, v36
  v_add_f32 v18, v18, v20
  v_add_f32 v19, v19, v21
  v_lshlrev_b32 v22, 16, v37
  v_and_b32 v23, s85, v37
  v_add_f32 v18, v18, v22
  v_mfma_f32_32x32x16_bf16 v[176:191], v[32:35], v[60:63], v[176:191]
  v_add_f32 v19, v19, v23
  v_lshlrev_b32 v24, 16, v38
  v_and_b32 v25, s85, v38
  v_add_f32 v18, v18, v24
  v_add_f32 v19, v19, v25
  v_lshlrev_b32 v26, 16, v39
  v_mfma_f32_32x32x16_bf16 v[240:255], v[36:39], v[60:63], v[240:255]
  v_and_b32 v27, s85, v39
  v_add_f32 v18, v18, v26
  v_add_f32 v19, v19, v27
  s_waitcnt lgkmcnt(0)
  v_mfma_f32_32x32x16_bf16 v[128:143], v[40:43], v[64:67], v[128:143]
  s_barrier
  ds_read_b64_tr_b16 v[32:33], v3 offset:49152
  ds_read_b64_tr_b16 v[34:35], v3 offset:50176
  v_lshlrev_b32 v20, 16, v40
  v_and_b32 v21, s85, v40
  v_add_f32 v16, v16, v20
  v_mfma_f32_32x32x16_bf16 v[192:207], v[44:47], v[64:67], v[192:207]
  ds_read_b128 v[48:51], v5 offset:0
  ds_read_b64_tr_b16 v[36:37], v3 offset:57344
  v_add_f32 v17, v17, v21
  v_lshlrev_b32 v22, 16, v41
  v_and_b32 v23, s85, v41
  v_mfma_f32_32x32x16_bf16 v[144:159], v[40:43], v[68:71], v[144:159]
  ds_read_b64_tr_b16 v[38:39], v3 offset:58368
  ds_read_b128 v[52:55], v5 offset:4096
  v_add_f32 v16, v16, v22
  v_add_f32 v17, v17, v23
  v_lshlrev_b32 v24, 16, v42
  v_perm_b32 v124, v110, v108, s82
  v_perm_b32 v125, v114, v112, s82
  v_perm_b32 v126, v118, v116, s82
  v_perm_b32 v127, v122, v120, s82
  buffer_store_dwordx4 v[124:127], v15, s[48:51], s74 offen sc0 sc1
  s_add_u32 s74, s74, 8448
  v_mfma_f32_32x32x16_bf16 v[208:223], v[44:47], v[68:71], v[208:223]
  ds_read_b128 v[56:59], v5 offset:8192
  ds_read_b128 v[60:63], v5 offset:12288
  v_and_b32 v25, s85, v42
  v_add_f32 v16, v16, v24
  v_add_f32 v17, v17, v25
  v_mfma_f32_32x32x16_bf16 v[160:175], v[40:43], v[72:75], v[160:175]
  v_lshlrev_b32 v26, 16, v43
  v_and_b32 v27, s85, v43
  v_add_f32 v16, v16, v26
  v_add_f32 v17, v17, v27
  v_xor_b32 v6, 98336, v8
  v_lshlrev_b32 v20, 16, v44
  v_mfma_f32_32x32x16_bf16 v[224:239], v[44:47], v[72:75], v[224:239]
  v_and_b32 v21, s85, v44
  v_add_f32 v18, v18, v20
  v_add_f32 v19, v19, v21
  v_lshlrev_b32 v22, 16, v45
  v_and_b32 v23, s85, v45
  v_add_f32 v18, v18, v22
  v_mfma_f32_32x32x16_bf16 v[176:191], v[40:43], v[76:79], v[176:191]
  v_add_f32 v19, v19, v23
  v_lshlrev_b32 v24, 16, v46
  v_and_b32 v25, s85, v46
  v_add_f32 v18, v18, v24
  v_add_f32 v19, v19, v25
  v_lshlrev_b32 v26, 16, v47
  v_mfma_f32_32x32x16_bf16 v[240:255], v[44:47], v[76:79], v[240:255]
  v_and_b32 v27, s85, v47
  v_add_f32 v18, v18, v26
  v_add_f32 v19, v19, v27
  s_waitcnt lgkmcnt(0)
  v_mfma_f32_32x32x16_bf16 v[128:143], v[32:35], v[48:51], v[128:143]
  ds_read_b64_tr_b16 v[40:41], v3 offset:53248
  ds_read_b64_tr_b16 v[42:43], v3 offset:54272
  v_lshlrev_b32 v20, 16, v32
  v_and_b32 v21, s85, v32
  v_add_f32 v16, v16, v20
  v_mfma_f32_32x32x16_bf16 v[192:207], v[36:39], v[48:51], v[192:207]
  ds_read_b128 v[64:67], v6 offset:0
  ds_read_b64_tr_b16 v[44:45], v3 offset:61440
  v_add_f32 v17, v17, v21
  v_lshlrev_b32 v22, 16, v33
  v_and_b32 v23, s85, v33
  v_mfma_f32_32x32x16_bf16 v[144:159], v[32:35], v[52:55], v[144:159]
  ds_read_b64_tr_b16 v[46:47], v3 offset:62464
  ds_read_b128 v[68:71], v6 offset:4096
  v_add_f32 v16, v16, v22
  v_add_f32 v17, v17, v23
  v_lshlrev_b32 v24, 16, v34
  v_perm_b32 v124, v110, v108, s83
  v_perm_b32 v125, v114, v112, s83
  v_perm_b32 v126, v118, v116, s83
  v_perm_b32 v127, v122, v120, s83
  buffer_store_dwordx4 v[124:127], v15, s[48:51], s74 offen sc0 sc1
  s_add_u32 s74, s74, 8448
  v_mfma_f32_32x32x16_bf16 v[208:223], v[36:39], v[52:55], v[208:223]
  ds_read_b128 v[72:75], v6 offset:8192
  ds_read_b128 v[76:79], v6 offset:12288
  v_and_b32 v25, s85, v34
  v_add_f32 v16, v16, v24
  v_add_f32 v17, v17, v25
  v_mfma_f32_32x32x16_bf16 v[160:175], v[32:35], v[56:59], v[160:175]
  v_lshlrev_b32 v26, 16, v35
  v_and_b32 v27, s85, v35
  v_add_f32 v16, v16, v26
  v_add_f32 v17, v17, v27
  v_xor_b32 v5, 98368, v8
  v_lshlrev_b32 v20, 16, v36
  v_mfma_f32_32x32x16_bf16 v[224:239], v[36:39], v[56:59], v[224:239]
  v_and_b32 v21, s85, v36
  v_add_f32 v18, v18, v20
  v_add_f32 v19, v19, v21
  v_lshlrev_b32 v22, 16, v37
  v_and_b32 v23, s85, v37
  v_add_f32 v18, v18, v22
  v_mfma_f32_32x32x16_bf16 v[176:191], v[32:35], v[60:63], v[176:191]
  v_add_f32 v19, v19, v23
  v_lshlrev_b32 v24, 16, v38
  v_and_b32 v25, s85, v38
  v_add_f32 v18, v18, v24
  v_add_f32 v19, v19, v25
  v_lshlrev_b32 v26, 16, v39
  v_mfma_f32_32x32x16_bf16 v[240:255], v[36:39], v[60:63], v[240:255]
  v_and_b32 v27, s85, v39
  v_add_f32 v18, v18, v26
  v_add_f32 v19, v19, v27
  s_waitcnt lgkmcnt(0)
  v_mfma_f32_32x32x16_bf16 v[128:143], v[40:43], v[64:67], v[128:143]
  s_barrier
  ds_read_b64_tr_b16 v[32:33], v4 offset:0
  ds_read_b64_tr_b16 v[34:35], v4 offset:1024
  v_lshlrev_b32 v20, 16, v40
  v_and_b32 v21, s85, v40
  v_add_f32 v16, v16, v20
  v_mfma_f32_32x32x16_bf16 v[192:207], v[44:47], v[64:67], v[192:207]
  ds_read_b128 v[48:51], v5 offset:0
  ds_read_b64_tr_b16 v[36:37], v4 offset:8192
  v_add_f32 v17, v17, v21
  v_lshlrev_b32 v22, 16, v41
  v_and_b32 v23, s85, v41
  v_mfma_f32_32x32x16_bf16 v[144:159], v[40:43], v[68:71], v[144:159]
  ds_read_b64_tr_b16 v[38:39], v4 offset:9216
  ds_read_b128 v[52:55], v5 offset:4096
  v_add_f32 v16, v16, v22
  v_add_f32 v17, v17, v23
  v_lshlrev_b32 v24, 16, v42
  s_cmp_eq_u32 s3, 0
  s_cbranch_scc1 gu_fla
gu_fla_ret:
  v_mfma_f32_32x32x16_bf16 v[208:223], v[44:47], v[68:71], v[208:223]
  ds_read_b128 v[56:59], v5 offset:8192
  ds_read_b128 v[60:63], v5 offset:12288
  v_and_b32 v25, s85, v42
  v_add_f32 v16, v16, v24
  v_add_f32 v17, v17, v25
  v_perm_b32 v124, v111, v109, s82
  v_perm_b32 v125, v115, v113, s82
  v_perm_b32 v126, v119, v117, s82
  v_perm_b32 v127, v123, v121, s82
  buffer_store_dwordx4 v[124:127], v15, s[48:51], s74 offen sc0 sc1
  s_add_u32 s74, s74, 8448
  v_mfma_f32_32x32x16_bf16 v[160:175], v[40:43], v[72:75], v[160:175]
  v_lshlrev_b32 v26, 16, v43
  v_and_b32 v27, s85, v43
  v_add_f32 v16, v16, v26
  v_add_f32 v17, v17, v27
  v_xor_b32 v6, 98400, v8
  v_lshlrev_b32 v20, 16, v44
  v_mfma_f32_32x32x16_bf16 v[224:239], v[44:47], v[72:75], v[224:239]
  v_and_b32 v21, s85, v44
  v_add_f32 v18, v18, v20
  v_add_f32 v19, v19, v21
  v_lshlrev_b32 v22, 16, v45
  v_and_b32 v23, s85, v45
  v_add_f32 v18, v18, v22
  v_mfma_f32_32x32x16_bf16 v[176:191], v[40:43], v[76:79], v[176:191]
  v_add_f32 v19, v19, v23
  v_lshlrev_b32 v24, 16, v46
  v_and_b32 v25, s85, v46
  v_add_f32 v18, v18, v24
  v_add_f32 v19, v19, v25
  v_lshlrev_b32 v26, 16, v47
  v_mfma_f32_32x32x16_bf16 v[240:255], v[44:47], v[76:79], v[240:255]
  v_and_b32 v27, s85, v47
  v_add_f32 v18, v18, v26
  v_add_f32 v19, v19, v27
  s_waitcnt lgkmcnt(0)
  v_mfma_f32_32x32x16_bf16 v[128:143], v[32:35], v[48:51], v[128:143]
  ds_read_b64_tr_b16 v[40:41], v4 offset:4096
  ds_read_b64_tr_b16 v[42:43], v4 offset:5120
  v_lshlrev_b32 v20, 16, v32
  v_and_b32 v21, s85, v32
  v_add_f32 v16, v16, v20
  v_mfma_f32_32x32x16_bf16 v[192:207], v[36:39], v[48:51], v[192:207]
  ds_read_b128 v[64:67], v6 offset:0
  ds_read_b64_tr_b16 v[44:45], v4 offset:12288
  v_add_f32 v17, v17, v21
  v_lshlrev_b32 v22, 16, v33
  v_and_b32 v23, s85, v33
  v_mfma_f32_32x32x16_bf16 v[144:159], v[32:35], v[52:55], v[144:159]
  ds_read_b64_tr_b16 v[46:47], v4 offset:13312
  ds_read_b128 v[68:71], v6 offset:4096
  v_add_f32 v16, v16, v22
  v_add_f32 v17, v17, v23
  v_lshlrev_b32 v24, 16, v34
  v_perm_b32 v124, v111, v109, s83
  v_perm_b32 v125, v115, v113, s83
  v_perm_b32 v126, v119, v117, s83
  v_perm_b32 v127, v123, v121, s83
  buffer_store_dwordx4 v[124:127], v15, s[48:51], s74 offen sc0 sc1
  v_mfma_f32_32x32x16_bf16 v[208:223], v[36:39], v[52:55], v[208:223]
  ds_read_b128 v[72:75], v6 offset:8192
  ds_read_b128 v[76:79], v6 offset:12288
  v_and_b32 v25, s85, v34
  v_add_f32 v16, v16, v24
  v_add_f32 v17, v17, v25
  v_mfma_f32_32x32x16_bf16 v[160:175], v[32:35], v[56:59], v[160:175]
  v_lshlrev_b32 v26, 16, v35
  v_and_b32 v27, s85, v35
  v_add_f32 v16, v16, v26
  v_add_f32 v17, v17, v27
  v_xor_b32 v5, 16384, v8
  v_lshlrev_b32 v20, 16, v36
  v_mfma_f32_32x32x16_bf16 v[224:239], v[36:39], v[56:59], v[224:239]
  v_and_b32 v21, s85, v36
  v_add_f32 v18, v18, v20
  v_add_f32 v19, v19, v21
  v_lshlrev_b32 v22, 16, v37
  v_and_b32 v23, s85, v37
  v_add_f32 v18, v18, v22
  v_mfma_f32_32x32x16_bf16 v[176:191], v[32:35], v[60:63], v[176:191]
  v_add_f32 v19, v19, v23
  v_lshlrev_b32 v24, 16, v38
  v_and_b32 v25, s85, v38
  v_add_f32 v18, v18, v24
  v_add_f32 v19, v19, v25
  v_lshlrev_b32 v26, 16, v39
  v_mfma_f32_32x32x16_bf16 v[240:255], v[36:39], v[60:63], v[240:255]
  v_and_b32 v27, s85, v39
  v_add_f32 v18, v18, v26
  v_add_f32 v19, v19, v27
  s_waitcnt lgkmcnt(0)
  v_mfma_f32_32x32x16_bf16 v[128:143], v[40:43], v[64:67], v[128:143]
  s_barrier
  ds_read_b64_tr_b16 v[32:33], v2 offset:32768
  ds_read_b64_tr_b16 v[34:35], v2 offset:33792
  v_lshlrev_b32 v20, 16, v40
  v_and_b32 v21, s85, v40
  v_add_f32 v16, v16, v20
  v_mfma_f32_32x32x16_bf16 v[192:207], v[44:47], v[64:67], v[192:207]
  ds_read_b128 v[48:51], v5 offset:0
  ds_read_b64_tr_b16 v[36:37], v2 offset:40960
  v_add_f32 v17, v17, v21
  v_lshlrev_b32 v22, 16, v41
  v_and_b32 v23, s85, v41
  v_mfma_f32_32x32x16_bf16 v[144:159], v[40:43], v[68:71], v[144:159]
  ds_read_b64_tr_b16 v[38:39], v2 offset:41984
  ds_read_b128 v[52:55], v5 offset:4096
  v_add_f32 v16, v16, v22
  v_add_f32 v17, v17, v23
  v_lshlrev_b32 v24, 16, v42
  v_mfma_f32_32x32x16_bf16 v[208:223], v[44:47], v[68:71], v[208:223]
  ds_read_b128 v[56:59], v5 offset:8192
  ds_read_b128 v[60:63], v5 offset:12288
  v_and_b32 v25, s85, v42
  v_add_f32 v16, v16, v24
  v_add_f32 v17, v17, v25
  v_mfma_f32_32x32x16_bf16 v[160:175], v[40:43], v[72:75], v[160:175]
  v_lshlrev_b32 v26, 16, v43
  v_and_b32 v27, s85, v43
  v_add_f32 v16, v16, v26
  v_add_f32 v17, v17, v27
  v_xor_b32 v6, 16416, v8
  v_lshlrev_b32 v20, 16, v44
  v_mfma_f32_32x32x16_bf16 v[224:239], v[44:47], v[72:75], v[224:239]
  v_and_b32 v21, s85, v44
  v_add_f32 v18, v18, v20
  v_add_f32 v19, v19, v21
  v_lshlrev_b32 v22, 16, v45
  v_and_b32 v23, s85, v45
  v_add_f32 v18, v18, v22
  v_mfma_f32_32x32x16_bf16 v[176:191], v[40:43], v[76:79], v[176:191]
  v_add_f32 v19, v19, v23
  v_lshlrev_b32 v24, 16, v46
  v_and_b32 v25, s85, v46
  v_add_f32 v18, v18, v24
  v_add_f32 v19, v19, v25
  v_lshlrev_b32 v26, 16, v47
  v_mfma_f32_32x32x16_bf16 v[240:255], v[44:47], v[76:79], v[240:255]
  v_and_b32 v27, s85, v47
  v_add_f32 v18, v18, v26
  v_add_f32 v19, v19, v27
  s_waitcnt lgkmcnt(0)
  v_mfma_f32_32x32x16_bf16 v[128:143], v[32:35], v[48:51], v[128:143]
  ds_read_b64_tr_b16 v[40:41], v2 offset:36864
  ds_read_b64_tr_b16 v[42:43], v2 offset:37888
  v_lshlrev_b32 v20, 16, v32
  v_and_b32 v21, s85, v32
  v_add_f32 v16, v16, v20
  v_mfma_f32_32x32x16_bf16 v[192:207], v[36:39], v[48:51], v[192:207]
  ds_read_b128 v[64:67], v6 offset:0
  ds_read_b64_tr_b16 v[44:45], v2 offset:45056
  v_add_f32 v17, v17, v21
  v_lshlrev_b32 v22, 16, v33
  v_and_b32 v23, s85, v33
  v_mfma_f32_32x32x16_bf16 v[144:159], v[32:35], v[52:55], v[144:159]
  ds_read_b64_tr_b16 v[46:47], v2 offset:46080
  ds_read_b128 v[68:71], v6 offset:4096
  v_add_f32 v16, v16, v22
  v_add_f32 v17, v17, v23
  v_lshlrev_b32 v24, 16, v34
  v_mfma_f32_32x32x16_bf16 v[208:223], v[36:39], v[52:55], v[208:223]
  ds_read_b128 v[72:75], v6 offset:8192
  ds_read_b128 v[76:79], v6 offset:12288
  v_and_b32 v25, s85, v34
  v_add_f32 v16, v16, v24
  v_add_f32 v17, v17, v25
  v_mfma_f32_32x32x16_bf16 v[160:175], v[32:35], v[56:59], v[160:175]
  v_lshlrev_b32 v26, 16, v35
  v_and_b32 v27, s85, v35
  v_add_f32 v16, v16, v26
  v_add_f32 v17, v17, v27
  v_xor_b32 v5, 16448, v8
  v_lshlrev_b32 v20, 16, v36
  v_mfma_f32_32x32x16_bf16 v[224:239], v[36:39], v[56:59], v[224:239]
  v_and_b32 v21, s85, v36
  v_add_f32 v18, v18, v20
  v_add_f32 v19, v19, v21
  v_lshlrev_b32 v22, 16, v37
  v_and_b32 v23, s85, v37
  v_add_f32 v18, v18, v22
  v_mfma_f32_32x32x16_bf16 v[176:191], v[32:35], v[60:63], v[176:191]
  v_add_f32 v19, v19, v23
  v_lshlrev_b32 v24, 16, v38
  v_and_b32 v25, s85, v38
  v_add_f32 v18, v18, v24
  v_add_f32 v19, v19, v25
  v_lshlrev_b32 v26, 16, v39
  v_mfma_f32_32x32x16_bf16 v[240:255], v[36:39], v[60:63], v[240:255]
  v_and_b32 v27, s85, v39
  v_add_f32 v18, v18, v26
  v_add_f32 v19, v19, v27
  s_waitcnt lgkmcnt(0)
  v_mfma_f32_32x32x16_bf16 v[128:143], v[40:43], v[64:67], v[128:143]
  s_barrier
  ds_read_b64_tr_b16 v[32:33], v2 offset:0
  ds_read_b64_tr_b16 v[34:35], v2 offset:1024
  v_lshlrev_b32 v20, 16, v40
  v_and_b32 v21, s85, v40
  v_add_f32 v16, v16, v20
  v_mfma_f32_32x32x16_bf16 v[192:207], v[44:47], v[64:67], v[192:207]
  ds_read_b128 v[48:51], v5 offset:0
  ds_read_b64_tr_b16 v[36:37], v2 offset:8192
  v_add_f32 v17, v17, v21
  v_lshlrev_b32 v22, 16, v41
  v_and_b32 v23, s85, v41
  v_mfma_f32_32x32x16_bf16 v[144:159], v[40:43], v[68:71], v[144:159]
  ds_read_b64_tr_b16 v[38:39], v2 offset:9216
  ds_read_b128 v[52:55], v5 offset:4096
  v_add_f32 v16, v16, v22
  v_add_f32 v17, v17, v23
  v_lshlrev_b32 v24, 16, v42
  v_mfma_f32_32x32x16_bf16 v[208:223], v[44:47], v[68:71], v[208:223]
  ds_read_b128 v[56:59], v5 offset:8192
  ds_read_b128 v[60:63], v5 offset:12288
  v_and_b32 v25, s85, v42
  v_add_f32 v16, v16, v24
  v_add_f32 v17, v17, v25
  v_mfma_f32_32x32x16_bf16 v[160:175], v[40:43], v[72:75], v[160:175]
  v_lshlrev_b32 v26, 16, v43
  v_and_b32 v27, s85, v43
  v_add_f32 v16, v16, v26
  v_add_f32 v17, v17, v27
  v_xor_b32 v6, 16480, v8
  v_lshlrev_b32 v20, 16, v44
  v_mfma_f32_32x32x16_bf16 v[224:239], v[44:47], v[72:75], v[224:239]
  v_and_b32 v21, s85, v44
  v_add_f32 v18, v18, v20
  v_add_f32 v19, v19, v21
  v_lshlrev_b32 v22, 16, v45
  v_and_b32 v23, s85, v45
  v_add_f32 v18, v18, v22
  v_mfma_f32_32x32x16_bf16 v[176:191], v[40:43], v[76:79], v[176:191]
  v_add_f32 v19, v19, v23
  v_lshlrev_b32 v24, 16, v46
  v_and_b32 v25, s85, v46
  v_add_f32 v18, v18, v24
  v_add_f32 v19, v19, v25
  v_lshlrev_b32 v26, 16, v47
  v_mfma_f32_32x32x16_bf16 v[240:255], v[44:47], v[76:79], v[240:255]
  v_and_b32 v27, s85, v47
  v_add_f32 v18, v18, v26
  v_add_f32 v19, v19, v27
  s_waitcnt lgkmcnt(0)
  v_mfma_f32_32x32x16_bf16 v[128:143], v[32:35], v[48:51], v[128:143]
  ds_read_b64_tr_b16 v[40:41], v2 offset:4096
  ds_read_b64_tr_b16 v[42:43], v2 offset:5120
  v_lshlrev_b32 v20, 16, v32
  v_and_b32 v21, s85, v32
  v_add_f32 v16, v16, v20
  v_mfma_f32_32x32x16_bf16 v[192:207], v[36:39], v[48:51], v[192:207]
  ds_read_b128 v[64:67], v6 offset:0
  ds_read_b64_tr_b16 v[44:45], v2 offset:12288
  v_add_f32 v17, v17, v21
  v_lshlrev_b32 v22, 16, v33
  v_and_b32 v23, s85, v33
  v_mfma_f32_32x32x16_bf16 v[144:159], v[32:35], v[52:55], v[144:159]
  ds_read_b64_tr_b16 v[46:47], v2 offset:13312
  ds_read_b128 v[68:71], v6 offset:4096
  v_add_f32 v16, v16, v22
  v_add_f32 v17, v17, v23
  v_lshlrev_b32 v24, 16, v34
  s_waitcnt vmcnt(0)
  buffer_atomic_add v30, v13, s[44:47], s76 offen sc1
  v_mfma_f32_32x32x16_bf16 v[208:223], v[36:39], v[52:55], v[208:223]
  ds_read_b128 v[72:75], v6 offset:8192
  ds_read_b128 v[76:79], v6 offset:12288
  v_and_b32 v25, s85, v34
  v_add_f32 v16, v16, v24
  v_add_f32 v17, v17, v25
  v_mfma_f32_32x32x16_bf16 v[160:175], v[32:35], v[56:59], v[160:175]
  v_lshlrev_b32 v26, 16, v35
  v_and_b32 v27, s85, v35
  v_add_f32 v16, v16, v26
  v_add_f32 v17, v17, v27
  v_xor_b32 v5, 65536, v8
  v_lshlrev_b32 v20, 16, v36
  v_mfma_f32_32x32x16_bf16 v[224:239], v[36:39], v[56:59], v[224:239]
  v_and_b32 v21, s85, v36
  v_add_f32 v18, v18, v20
  v_add_f32 v19, v19, v21
  v_lshlrev_b32 v22, 16, v37
  v_and_b32 v23, s85, v37
  v_add_f32 v18, v18, v22
  v_mfma_f32_32x32x16_bf16 v[176:191], v[32:35], v[60:63], v[176:191]
  v_add_f32 v19, v19, v23
  v_lshlrev_b32 v24, 16, v38
  v_and_b32 v25, s85, v38
  v_add_f32 v18, v18, v24
  v_add_f32 v19, v19, v25
  v_lshlrev_b32 v26, 16, v39
  v_mfma_f32_32x32x16_bf16 v[240:255], v[36:39], v[60:63], v[240:255]
  v_and_b32 v27, s85, v39
  v_add_f32 v18, v18, v26
  v_add_f32 v19, v19, v27
  s_waitcnt lgkmcnt(0)
  v_mfma_f32_32x32x16_bf16 v[128:143], v[40:43], v[64:67], v[128:143]
  s_barrier
  ds_read_b64_tr_b16 v[32:33], v3 offset:16384
  ds_read_b64_tr_b16 v[34:35], v3 offset:17408
  v_lshlrev_b32 v20, 16, v40
  v_and_b32 v21, s85, v40
  v_add_f32 v16, v16, v20
  v_mfma_f32_32x32x16_bf16 v[192:207], v[44:47], v[64:67], v[192:207]
  ds_read_b128 v[48:51], v5 offset:0
  ds_read_b64_tr_b16 v[36:37], v3 offset:24576
  v_add_f32 v17, v17, v21
  v_lshlrev_b32 v22, 16, v41
  v_and_b32 v23, s85, v41
  v_mfma_f32_32x32x16_bf16 v[144:159], v[40:43], v[68:71], v[144:159]
  ds_read_b64_tr_b16 v[38:39], v3 offset:25600
  ds_read_b128 v[52:55], v5 offset:4096
  v_add_f32 v16, v16, v22
  v_add_f32 v17, v17, v23
  v_lshlrev_b32 v24, 16, v42
  v_mfma_f32_32x32x16_bf16 v[208:223], v[44:47], v[68:71], v[208:223]
  ds_read_b128 v[56:59], v5 offset:8192
  ds_read_b128 v[60:63], v5 offset:12288
  v_and_b32 v25, s85, v42
  v_add_f32 v16, v16, v24
  v_add_f32 v17, v17, v25
  v_mfma_f32_32x32x16_bf16 v[160:175], v[40:43], v[72:75], v[160:175]
  v_lshlrev_b32 v26, 16, v43
  v_and_b32 v27, s85, v43
  v_add_f32 v16, v16, v26
  v_add_f32 v17, v17, v27
  v_xor_b32 v6, 65568, v8
  v_lshlrev_b32 v20, 16, v44
  v_mfma_f32_32x32x16_bf16 v[224:239], v[44:47], v[72:75], v[224:239]
  v_and_b32 v21, s85, v44
  v_add_f32 v18, v18, v20
  v_add_f32 v19, v19, v21
  v_lshlrev_b32 v22, 16, v45
  v_and_b32 v23, s85, v45
  v_add_f32 v18, v18, v22
  v_mfma_f32_32x32x16_bf16 v[176:191], v[40:43], v[76:79], v[176:191]
  v_add_f32 v19, v19, v23
  v_lshlrev_b32 v24, 16, v46
  v_and_b32 v25, s85, v46
  v_add_f32 v18, v18, v24
  v_add_f32 v19, v19, v25
  v_lshlrev_b32 v26, 16, v47
  v_mfma_f32_32x32x16_bf16 v[240:255], v[44:47], v[76:79], v[240:255]
  v_and_b32 v27, s85, v47
  v_add_f32 v18, v18, v26
  v_add_f32 v19, v19, v27
  s_waitcnt lgkmcnt(0)
  v_mfma_f32_32x32x16_bf16 v[128:143], v[32:35], v[48:51], v[128:143]
  ds_read_b64_tr_b16 v[40:41], v3 offset:20480
  ds_read_b64_tr_b16 v[42:43], v3 offset:21504
  v_lshlrev_b32 v20, 16, v32
  v_and_b32 v21, s85, v32
  v_add_f32 v16, v16, v20
  v_mfma_f32_32x32x16_bf16 v[192:207], v[36:39], v[48:51], v[192:207]
  ds_read_b128 v[64:67], v6 offset:0
  ds_read_b64_tr_b16 v[44:45], v3 offset:28672
  v_add_f32 v17, v17, v21
  v_lshlrev_b32 v22, 16, v33
  v_and_b32 v23, s85, v33
  v_mfma_f32_32x32x16_bf16 v[144:159], v[32:35], v[52:55], v[144:159]
  ds_read_b64_tr_b16 v[46:47], v3 offset:29696
  ds_read_b128 v[68:71], v6 offset:4096
  v_add_f32 v16, v16, v22
  v_add_f32 v17, v17, v23
  v_lshlrev_b32 v24, 16, v34
  v_mfma_f32_32x32x16_bf16 v[208:223], v[36:39], v[52:55], v[208:223]
  ds_read_b128 v[72:75], v6 offset:8192
  ds_read_b128 v[76:79], v6 offset:12288
  v_and_b32 v25, s85, v34
  v_add_f32 v16, v16, v24
  v_add_f32 v17, v17, v25
  v_mfma_f32_32x32x16_bf16 v[160:175], v[32:35], v[56:59], v[160:175]
  v_lshlrev_b32 v26, 16, v35
  v_and_b32 v27, s85, v35
  v_add_f32 v16, v16, v26
  v_add_f32 v17, v17, v27
  v_xor_b32 v5, 65600, v8
  v_lshlrev_b32 v20, 16, v36
  v_mfma_f32_32x32x16_bf16 v[224:239], v[36:39], v[56:59], v[224:239]
  v_and_b32 v21, s85, v36
  v_add_f32 v18, v18, v20
  v_add_f32 v19, v19, v21
  v_lshlrev_b32 v22, 16, v37
  v_and_b32 v23, s85, v37
  v_add_f32 v18, v18, v22
  v_mfma_f32_32x32x16_bf16 v[176:191], v[32:35], v[60:63], v[176:191]
  v_add_f32 v19, v19, v23
  v_lshlrev_b32 v24, 16, v38
  v_and_b32 v25, s85, v38
  v_add_f32 v18, v18, v24
  v_add_f32 v19, v19, v25
  v_lshlrev_b32 v26, 16, v39
  v_mfma_f32_32x32x16_bf16 v[240:255], v[36:39], v[60:63], v[240:255]
  v_and_b32 v27, s85, v39
  v_add_f32 v18, v18, v26
  v_add_f32 v19, v19, v27
  s_waitcnt lgkmcnt(0)
  v_mfma_f32_32x32x16_bf16 v[128:143], v[40:43], v[64:67], v[128:143]
  s_barrier
  ds_read_b64_tr_b16 v[32:33], v2 offset:49152
  ds_read_b64_tr_b16 v[34:35], v2 offset:50176
  v_lshlrev_b32 v20, 16, v40
  v_and_b32 v21, s85, v40
  v_add_f32 v16, v16, v20
  v_mfma_f32_32x32x16_bf16 v[192:207], v[44:47], v[64:67], v[192:207]
  ds_read_b128 v[48:51], v5 offset:0
  ds_read_b64_tr_b16 v[36:37], v2 offset:57344
  v_add_f32 v17, v17, v21
  v_lshlrev_b32 v22, 16, v41
  v_and_b32 v23, s85, v41
  v_mfma_f32_32x32x16_bf16 v[144:159], v[40:43], v[68:71], v[144:159]
  ds_read_b64_tr_b16 v[38:39], v2 offset:58368
  ds_read_b128 v[52:55], v5 offset:4096
  v_add_f32 v16, v16, v22
  v_add_f32 v17, v17, v23
  v_lshlrev_b32 v24, 16, v42
  buffer_load_dword v10, v9, s[44:47], s78 offen sc1
  v_mfma_f32_32x32x16_bf16 v[208:223], v[44:47], v[68:71], v[208:223]
  ds_read_b128 v[56:59], v5 offset:8192
  ds_read_b128 v[60:63], v5 offset:12288
  v_and_b32 v25, s85, v42
  v_add_f32 v16, v16, v24
  v_add_f32 v17, v17, v25
  v_mfma_f32_32x32x16_bf16 v[160:175], v[40:43], v[72:75], v[160:175]
  v_lshlrev_b32 v26, 16, v43
  v_and_b32 v27, s85, v43
  v_add_f32 v16, v16, v26
  v_add_f32 v17, v17, v27
  v_xor_b32 v6, 65632, v8
  v_lshlrev_b32 v20, 16, v44
  v_mfma_f32_32x32x16_bf16 v[224:239], v[44:47], v[72:75], v[224:239]
  v_and_b32 v21, s85, v44
  v_add_f32 v18, v18, v20
  v_add_f32 v19, v19, v21
  v_lshlrev_b32 v22, 16, v45
  v_and_b32 v23, s85, v45
  v_add_f32 v18, v18, v22
  v_mfma_f32_32x32x16_bf16 v[176:191], v[40:43], v[76:79], v[176:191]
  v_add_f32 v19, v19, v23
  v_lshlrev_b32 v24, 16, v46
  v_and_b32 v25, s85, v46
  v_add_f32 v18, v18, v24
  v_add_f32 v19, v19, v25
  v_lshlrev_b32 v26, 16, v47
  v_mfma_f32_32x32x16_bf16 v[240:255], v[44:47], v[76:79], v[240:255]
  v_and_b32 v27, s85, v47
  v_add_f32 v18, v18, v26
  v_add_f32 v19, v19, v27
  s_waitcnt lgkmcnt(0)
  v_mfma_f32_32x32x16_bf16 v[128:143], v[32:35], v[48:51], v[128:143]
  ds_read_b64_tr_b16 v[40:41], v2 offset:53248
  ds_read_b64_tr_b16 v[42:43], v2 offset:54272
  v_lshlrev_b32 v20, 16, v32
  v_and_b32 v21, s85, v32
  v_add_f32 v16, v16, v20
  v_mfma_f32_32x32x16_bf16 v[192:207], v[36:39], v[48:51], v[192:207]
  ds_read_b128 v[64:67], v6 offset:0
  ds_read_b64_tr_b16 v[44:45], v2 offset:61440
  v_add_f32 v17, v17, v21
  v_lshlrev_b32 v22, 16, v33
  v_and_b32 v23, s85, v33
  v_mfma_f32_32x32x16_bf16 v[144:159], v[32:35], v[52:55], v[144:159]
  ds_read_b64_tr_b16 v[46:47], v2 offset:62464
  ds_read_b128 v[68:71], v6 offset:4096
  v_add_f32 v16, v16, v22
  v_add_f32 v17, v17, v23
  v_lshlrev_b32 v24, 16, v34
  buffer_load_dword v84, v14, s[52:55], s70 offen offset:0 sc1
  v_mfma_f32_32x32x16_bf16 v[208:223], v[36:39], v[52:55], v[208:223]
  ds_read_b128 v[72:75], v6 offset:8192
  ds_read_b128 v[76:79], v6 offset:12288
  v_and_b32 v25, s85, v34
  v_add_f32 v16, v16, v24
  v_add_f32 v17, v17, v25
  buffer_load_dword v88, v14, s[52:55], s70 offen offset:128 sc1
  v_mfma_f32_32x32x16_bf16 v[160:175], v[32:35], v[56:59], v[160:175]
  v_lshlrev_b32 v26, 16, v35
  v_and_b32 v27, s85, v35
  v_add_f32 v16, v16, v26
  v_add_f32 v17, v17, v27
  v_xor_b32 v5, 114688, v8
  v_lshlrev_b32 v20, 16, v36
  buffer_load_dword v92, v14, s[52:55], s70 offen offset:256 sc1
  v_mfma_f32_32x32x16_bf16 v[224:239], v[36:39], v[56:59], v[224:239]
  v_and_b32 v21, s85, v36
  v_add_f32 v18, v18, v20
  v_add_f32 v19, v19, v21
  v_lshlrev_b32 v22, 16, v37
  v_and_b32 v23, s85, v37
  v_add_f32 v18, v18, v22
  buffer_load_dword v96, v14, s[52:55], s70 offen offset:384 sc1
  v_mfma_f32_32x32x16_bf16 v[176:191], v[32:35], v[60:63], v[176:191]
  v_add_f32 v19, v19, v23
  v_lshlrev_b32 v24, 16, v38
  v_and_b32 v25, s85, v38
  v_add_f32 v18, v18, v24
  v_add_f32 v19, v19, v25
  v_lshlrev_b32 v26, 16, v39
  v_mfma_f32_32x32x16_bf16 v[240:255], v[36:39], v[60:63], v[240:255]
  v_and_b32 v27, s85, v39
  v_add_f32 v18, v18, v26
  v_add_f32 v19, v19, v27
  s_waitcnt lgkmcnt(0)
  v_mfma_f32_32x32x16_bf16 v[128:143], v[40:43], v[64:67], v[128:143]
  s_barrier
  ds_read_b64_tr_b16 v[32:33], v4 offset:0
  ds_read_b64_tr_b16 v[34:35], v4 offset:1024
  v_lshlrev_b32 v20, 16, v40
  v_and_b32 v21, s85, v40
  v_add_f32 v16, v16, v20
  v_mfma_f32_32x32x16_bf16 v[192:207], v[44:47], v[64:67], v[192:207]
  ds_read_b128 v[48:51], v5 offset:0
  ds_read_b64_tr_b16 v[36:37], v4 offset:8192
  v_add_f32 v17, v17, v21
  v_lshlrev_b32 v22, 16, v41
  v_and_b32 v23, s85, v41
  v_mfma_f32_32x32x16_bf16 v[144:159], v[40:43], v[68:71], v[144:159]
  ds_read_b64_tr_b16 v[38:39], v4 offset:9216
  ds_read_b128 v[52:55], v5 offset:4096
  v_add_f32 v16, v16, v22
  v_add_f32 v17, v17, v23
  v_lshlrev_b32 v24, 16, v42
  v_mfma_f32_32x32x16_bf16 v[208:223], v[44:47], v[68:71], v[208:223]
  ds_read_b128 v[56:59], v5 offset:8192
  ds_read_b128 v[60:63], v5 offset:12288
  v_and_b32 v25, s85, v42
  v_add_f32 v16, v16, v24
  v_add_f32 v17, v17, v25
  v_mfma_f32_32x32x16_bf16 v[160:175], v[40:43], v[72:75], v[160:175]
  v_lshlrev_b32 v26, 16, v43
  v_and_b32 v27, s85, v43
  v_add_f32 v16, v16, v26
  v_add_f32 v17, v17, v27
  v_xor_b32 v6, 114720, v8
  v_lshlrev_b32 v20, 16, v44
  v_mfma_f32_32x32x16_bf16 v[224:239], v[44:47], v[72:75], v[224:239]
  v_and_b32 v21, s85, v44
  v_add_f32 v18, v18, v20
  v_add_f32 v19, v19, v21
  v_lshlrev_b32 v22, 16, v45
  v_and_b32 v23, s85, v45
  v_add_f32 v18, v18, v22
  v_mfma_f32_32x32x16_bf16 v[176:191], v[40:43], v[76:79], v[176:191]
  v_add_f32 v19, v19, v23
  v_lshlrev_b32 v24, 16, v46
  v_and_b32 v25, s85, v46
  v_add_f32 v18, v18, v24
  v_add_f32 v19, v19, v25
  v_lshlrev_b32 v26, 16, v47
  v_mfma_f32_32x32x16_bf16 v[240:255], v[44:47], v[76:79], v[240:255]
  v_and_b32 v27, s85, v47
  v_add_f32 v18, v18, v26
  v_add_f32 v19, v19, v27
  s_waitcnt lgkmcnt(0)
  v_mfma_f32_32x32x16_bf16 v[128:143], v[32:35], v[48:51], v[128:143]
  ds_read_b64_tr_b16 v[40:41], v4 offset:4096
  ds_read_b64_tr_b16 v[42:43], v4 offset:5120
  v_lshlrev_b32 v20, 16, v32
  v_and_b32 v21, s85, v32
  v_add_f32 v16, v16, v20
  v_mfma_f32_32x32x16_bf16 v[192:207], v[36:39], v[48:51], v[192:207]
  ds_read_b128 v[64:67], v6 offset:0
  ds_read_b64_tr_b16 v[44:45], v4 offset:12288
  v_add_f32 v17, v17, v21
  v_lshlrev_b32 v22, 16, v33
  v_and_b32 v23, s85, v33
  v_mfma_f32_32x32x16_bf16 v[144:159], v[32:35], v[52:55], v[144:159]
  ds_read_b64_tr_b16 v[46:47], v4 offset:13312
  ds_read_b128 v[68:71], v6 offset:4096
  v_add_f32 v16, v16, v22
  v_add_f32 v17, v17, v23
  v_lshlrev_b32 v24, 16, v34
  s_waitcnt vmcnt(4)
  v_cmp_ne_u32 vcc, 32, v10
  s_nop 1
  s_cmp_eq_u64 vcc, 0
  s_cselect_b64 exec, 1, 0
  ds_write_b32 v7, v30 offset:4
  s_mov_b64 exec, -1
  v_mfma_f32_32x32x16_bf16 v[208:223], v[36:39], v[52:55], v[208:223]
  ds_read_b128 v[72:75], v6 offset:8192
  ds_read_b128 v[76:79], v6 offset:12288
  v_and_b32 v25, s85, v34
  v_add_f32 v16, v16, v24
  v_add_f32 v17, v17, v25
  v_mfma_f32_32x32x16_bf16 v[160:175], v[32:35], v[56:59], v[160:175]
  v_lshlrev_b32 v26, 16, v35
  v_and_b32 v27, s85, v35
  v_add_f32 v16, v16, v26
  v_add_f32 v17, v17, v27
  v_xor_b32 v5, 114752, v8
  v_lshlrev_b32 v20, 16, v36
  v_mfma_f32_32x32x16_bf16 v[224:239], v[36:39], v[56:59], v[224:239]
  v_and_b32 v21, s85, v36
  v_add_f32 v18, v18, v20
  v_add_f32 v19, v19, v21
  v_lshlrev_b32 v22, 16, v37
  v_and_b32 v23, s85, v37
  v_add_f32 v18, v18, v22
  v_mfma_f32_32x32x16_bf16 v[176:191], v[32:35], v[60:63], v[176:191]
  v_add_f32 v19, v19, v23
  v_lshlrev_b32 v24, 16, v38
  v_and_b32 v25, s85, v38
  v_add_f32 v18, v18, v24
  v_add_f32 v19, v19, v25
  v_lshlrev_b32 v26, 16, v39
  v_mfma_f32_32x32x16_bf16 v[240:255], v[36:39], v[60:63], v[240:255]
  v_and_b32 v27, s85, v39
  v_add_f32 v18, v18, v26
  v_add_f32 v19, v19, v27
  s_waitcnt lgkmcnt(0)
  v_mfma_f32_32x32x16_bf16 v[128:143], v[40:43], v[64:67], v[128:143]
  s_barrier
  ds_read_b64_tr_b16 v[32:33], v3 offset:32768
  ds_read_b64_tr_b16 v[34:35], v3 offset:33792
  v_lshlrev_b32 v20, 16, v40
  v_and_b32 v21, s85, v40
  v_add_f32 v16, v16, v20
  v_mfma_f32_32x32x16_bf16 v[192:207], v[44:47], v[64:67], v[192:207]
  ds_read_b128 v[48:51], v5 offset:0
  ds_read_b64_tr_b16 v[36:37], v3 offset:40960
  v_add_f32 v17, v17, v21
  v_lshlrev_b32 v22, 16, v41
  v_and_b32 v23, s85, v41
  v_mfma_f32_32x32x16_bf16 v[144:159], v[40:43], v[68:71], v[144:159]
  ds_read_b64_tr_b16 v[38:39], v3 offset:41984
  ds_read_b128 v[52:55], v5 offset:4096
  v_add_f32 v16, v16, v22
  v_add_f32 v17, v17, v23
  v_lshlrev_b32 v24, 16, v42
  v_mfma_f32_32x32x16_bf16 v[208:223], v[44:47], v[68:71], v[208:223]
  ds_read_b128 v[56:59], v5 offset:8192
  ds_read_b128 v[60:63], v5 offset:12288
  v_and_b32 v25, s85, v42
  v_add_f32 v16, v16, v24
  v_add_f32 v17, v17, v25
  v_mfma_f32_32x32x16_bf16 v[160:175], v[40:43], v[72:75], v[160:175]
  v_lshlrev_b32 v26, 16, v43
  v_and_b32 v27, s85, v43
  v_add_f32 v16, v16, v26
  v_add_f32 v17, v17, v27
  v_xor_b32 v6, 114784, v8
  v_lshlrev_b32 v20, 16, v44
  v_mfma_f32_32x32x16_bf16 v[224:239], v[44:47], v[72:75], v[224:239]
  v_and_b32 v21, s85, v44
  v_add_f32 v18, v18, v20
  v_add_f32 v19, v19, v21
  v_lshlrev_b32 v22, 16, v45
  v_and_b32 v23, s85, v45
  v_add_f32 v18, v18, v22
  v_mfma_f32_32x32x16_bf16 v[176:191], v[40:43], v[76:79], v[176:191]
  v_add_f32 v19, v19, v23
  v_lshlrev_b32 v24, 16, v46
  v_and_b32 v25, s85, v46
  v_add_f32 v18, v18, v24
  v_add_f32 v19, v19, v25
  v_lshlrev_b32 v26, 16, v47
  v_mfma_f32_32x32x16_bf16 v[240:255], v[44:47], v[76:79], v[240:255]
  v_and_b32 v27, s85, v47
  v_add_f32 v18, v18, v26
  v_add_f32 v19, v19, v27
  s_waitcnt lgkmcnt(0)
  v_mfma_f32_32x32x16_bf16 v[128:143], v[32:35], v[48:51], v[128:143]
  ds_read_b64_tr_b16 v[40:41], v3 offset:36864
  ds_read_b64_tr_b16 v[42:43], v3 offset:37888
  v_lshlrev_b32 v20, 16, v32
  v_and_b32 v21, s85, v32
  v_add_f32 v16, v16, v20
  v_mfma_f32_32x32x16_bf16 v[192:207], v[36:39], v[48:51], v[192:207]
  ds_read_b128 v[64:67], v6 offset:0
  ds_read_b64_tr_b16 v[44:45], v3 offset:45056
  v_add_f32 v17, v17, v21
  v_lshlrev_b32 v22, 16, v33
  v_and_b32 v23, s85, v33
  v_mfma_f32_32x32x16_bf16 v[144:159], v[32:35], v[52:55], v[144:159]
  ds_read_b64_tr_b16 v[46:47], v3 offset:46080
  ds_read_b128 v[68:71], v6 offset:4096
  v_add_f32 v16, v16, v22
  v_add_f32 v17, v17, v23
  v_lshlrev_b32 v24, 16, v34
  v_mfma_f32_32x32x16_bf16 v[208:223], v[36:39], v[52:55], v[208:223]
  ds_read_b128 v[72:75], v6 offset:8192
  ds_read_b128 v[76:79], v6 offset:12288
  v_and_b32 v25, s85, v34
  v_add_f32 v16, v16, v24
  v_add_f32 v17, v17, v25
  v_mfma_f32_32x32x16_bf16 v[160:175], v[32:35], v[56:59], v[160:175]
  v_lshlrev_b32 v26, 16, v35
  v_and_b32 v27, s85, v35
  v_add_f32 v16, v16, v26
  v_add_f32 v17, v17, v27
  v_xor_b32 v5, 32768, v8
  v_lshlrev_b32 v20, 16, v36
  v_mfma_f32_32x32x16_bf16 v[224:239], v[36:39], v[56:59], v[224:239]
  v_and_b32 v21, s85, v36
  v_add_f32 v18, v18, v20
  v_add_f32 v19, v19, v21
  v_lshlrev_b32 v22, 16, v37
  v_and_b32 v23, s85, v37
  v_add_f32 v18, v18, v22
  v_mfma_f32_32x32x16_bf16 v[176:191], v[32:35], v[60:63], v[176:191]
  v_add_f32 v19, v19, v23
  v_lshlrev_b32 v24, 16, v38
  v_and_b32 v25, s85, v38
  v_add_f32 v18, v18, v24
  v_add_f32 v19, v19, v25
  v_lshlrev_b32 v26, 16, v39
  v_mfma_f32_32x32x16_bf16 v[240:255], v[36:39], v[60:63], v[240:255]
  v_and_b32 v27, s85, v39
  v_add_f32 v18, v18, v26
  v_add_f32 v19, v19, v27
  s_waitcnt lgkmcnt(0)
  v_mfma_f32_32x32x16_bf16 v[128:143], v[40:43], v[64:67], v[128:143]
  s_mov_b64 exec, 1
  ds_add_u32 v7, v30 offset:48
  s_mov_b64 exec, -1
  ds_read_b64_tr_b16 v[32:33], v2 offset:0
  ds_read_b64_tr_b16 v[34:35], v2 offset:1024
  v_lshlrev_b32 v20, 16, v40
  v_and_b32 v21, s85, v40
  v_add_f32 v16, v16, v20
  v_mfma_f32_32x32x16_bf16 v[192:207], v[44:47], v[64:67], v[192:207]
  ds_read_b128 v[48:51], v5 offset:0
  ds_read_b64_tr_b16 v[36:37], v2 offset:8192
  v_add_f32 v17, v17, v21
  v_lshlrev_b32 v22, 16, v41
  v_and_b32 v23, s85, v41
  v_mfma_f32_32x32x16_bf16 v[144:159], v[40:43], v[68:71], v[144:159]
  ds_read_b64_tr_b16 v[38:39], v2 offset:9216
  ds_read_b128 v[52:55], v5 offset:4096
  v_add_f32 v16, v16, v22
  v_add_f32 v17, v17, v23
  v_lshlrev_b32 v24, 16, v42
  v_mfma_f32_32x32x16_bf16 v[208:223], v[44:47], v[68:71], v[208:223]
  ds_read_b128 v[56:59], v5 offset:8192
  ds_read_b128 v[60:63], v5 offset:12288
  v_and_b32 v25, s85, v42
  v_add_f32 v16, v16, v24
  v_add_f32 v17, v17, v25
  v_mfma_f32_32x32x16_bf16 v[160:175], v[40:43], v[72:75], v[160:175]
  v_lshlrev_b32 v26, 16, v43
  v_and_b32 v27, s85, v43
  v_add_f32 v16, v16, v26
  v_add_f32 v17, v17, v27
  v_xor_b32 v6, 32800, v8
  v_lshlrev_b32 v20, 16, v44
  v_mfma_f32_32x32x16_bf16 v[224:239], v[44:47], v[72:75], v[224:239]
  v_and_b32 v21, s85, v44
  v_add_f32 v18, v18, v20
  v_add_f32 v19, v19, v21
  v_lshlrev_b32 v22, 16, v45
  v_and_b32 v23, s85, v45
  v_add_f32 v18, v18, v22
  v_mfma_f32_32x32x16_bf16 v[176:191], v[40:43], v[76:79], v[176:191]
  v_add_f32 v19, v19, v23
  v_lshlrev_b32 v24, 16, v46
  v_and_b32 v25, s85, v46
  v_add_f32 v18, v18, v24
  v_add_f32 v19, v19, v25
  v_lshlrev_b32 v26, 16, v47
  v_mfma_f32_32x32x16_bf16 v[240:255], v[44:47], v[76:79], v[240:255]
  v_and_b32 v27, s85, v47
  v_add_f32 v18, v18, v26
  v_add_f32 v19, v19, v27
  s_waitcnt lgkmcnt(0)
  v_mfma_f32_32x32x16_bf16 v[128:143], v[32:35], v[48:51], v[128:143]
  ds_read_b64_tr_b16 v[40:41], v2 offset:4096
  ds_read_b64_tr_b16 v[42:43], v2 offset:5120
  v_lshlrev_b32 v20, 16, v32
  v_and_b32 v21, s85, v32
  v_add_f32 v16, v16, v20
  v_mfma_f32_32x32x16_bf16 v[192:207], v[36:39], v[48:51], v[192:207]
  ds_read_b128 v[64:67], v6 offset:0
  ds_read_b64_tr_b16 v[44:45], v2 offset:12288
  v_add_f32 v17, v17, v21
  v_lshlrev_b32 v22, 16, v33
  v_and_b32 v23, s85, v33
  v_mfma_f32_32x32x16_bf16 v[144:159], v[32:35], v[52:55], v[144:159]
  ds_read_b64_tr_b16 v[46:47], v2 offset:13312
  ds_read_b128 v[68:71], v6 offset:4096
  v_add_f32 v16, v16, v22
  v_add_f32 v17, v17, v23
  v_lshlrev_b32 v24, 16, v34
  v_mfma_f32_32x32x16_bf16 v[208:223], v[36:39], v[52:55], v[208:223]
  ds_read_b128 v[72:75], v6 offset:8192
  ds_read_b128 v[76:79], v6 offset:12288
  v_and_b32 v25, s85, v34
  v_add_f32 v16, v16, v24
  v_add_f32 v17, v17, v25
  v_mfma_f32_32x32x16_bf16 v[160:175], v[32:35], v[56:59], v[160:175]
  v_lshlrev_b32 v26, 16, v35
  v_and_b32 v27, s85, v35
  v_add_f32 v16, v16, v26
  v_add_f32 v17, v17, v27
  v_xor_b32 v5, 32832, v8
  v_lshlrev_b32 v20, 16, v36
  v_mfma_f32_32x32x16_bf16 v[224:239], v[36:39], v[56:59], v[224:239]
  v_and_b32 v21, s85, v36
  v_add_f32 v18, v18, v20
  v_add_f32 v19, v19, v21
  v_lshlrev_b32 v22, 16, v37
  v_and_b32 v23, s85, v37
  v_add_f32 v18, v18, v22
  v_mfma_f32_32x32x16_bf16 v[176:191], v[32:35], v[60:63], v[176:191]
  v_add_f32 v19, v19, v23
  v_lshlrev_b32 v24, 16, v38
  v_and_b32 v25, s85, v38
  v_add_f32 v18, v18, v24
  v_add_f32 v19, v19, v25
  v_lshlrev_b32 v26, 16, v39
  v_mfma_f32_32x32x16_bf16 v[240:255], v[36:39], v[60:63], v[240:255]
  v_and_b32 v27, s85, v39
  v_add_f32 v18, v18, v26
  v_add_f32 v19, v19, v27
  s_waitcnt lgkmcnt(0)
  v_mfma_f32_32x32x16_bf16 v[128:143], v[40:43], v[64:67], v[128:143]
  s_mov_b64 exec, 1
  ds_add_u32 v7, v30 offset:52
  s_mov_b64 exec, -1
  ds_read_b64_tr_b16 v[32:33], v2 offset:16384
  ds_read_b64_tr_b16 v[34:35], v2 offset:17408
  v_lshlrev_b32 v20, 16, v40
  v_and_b32 v21, s85, v40
  v_add_f32 v16, v16, v20
  v_mfma_f32_32x32x16_bf16 v[192:207], v[44:47], v[64:67], v[192:207]
  ds_read_b128 v[48:51], v5 offset:0
  ds_read_b64_tr_b16 v[36:37], v2 offset:24576
  v_add_f32 v17, v17, v21
  v_lshlrev_b32 v22, 16, v41
  v_and_b32 v23, s85, v41
  v_mfma_f32_32x32x16_bf16 v[144:159], v[40:43], v[68:71], v[144:159]
  ds_read_b64_tr_b16 v[38:39], v2 offset:25600
  ds_read_b128 v[52:55], v5 offset:4096
  v_add_f32 v16, v16, v22
  v_add_f32 v17, v17, v23
  v_lshlrev_b32 v24, 16, v42
  v_mfma_f32_32x32x16_bf16 v[208:223], v[44:47], v[68:71], v[208:223]
  ds_read_b128 v[56:59], v5 offset:8192
  ds_read_b128 v[60:63], v5 offset:12288
  v_and_b32 v25, s85, v42
  v_add_f32 v16, v16, v24
  v_add_f32 v17, v17, v25
  v_mfma_f32_32x32x16_bf16 v[160:175], v[40:43], v[72:75], v[160:175]
  v_lshlrev_b32 v26, 16, v43
  v_and_b32 v27, s85, v43
  v_add_f32 v16, v16, v26
  v_add_f32 v17, v17, v27
  v_xor_b32 v6, 32864, v8
  v_lshlrev_b32 v20, 16, v44
  v_mfma_f32_32x32x16_bf16 v[224:239], v[44:47], v[72:75], v[224:239]
  v_and_b32 v21, s85, v44
  v_add_f32 v18, v18, v20
  v_add_f32 v19, v19, v21
  v_lshlrev_b32 v22, 16, v45
  v_and_b32 v23, s85, v45
  v_add_f32 v18, v18, v22
  v_mfma_f32_32x32x16_bf16 v[176:191], v[40:43], v[76:79], v[176:191]
  v_add_f32 v19, v19, v23
  v_lshlrev_b32 v24, 16, v46
  v_and_b32 v25, s85, v46
  v_add_f32 v18, v18, v24
  v_add_f32 v19, v19, v25
  v_lshlrev_b32 v26, 16, v47
  v_mfma_f32_32x32x16_bf16 v[240:255], v[44:47], v[76:79], v[240:255]
  v_and_b32 v27, s85, v47
  v_add_f32 v18, v18, v26
  v_add_f32 v19, v19, v27
  s_waitcnt lgkmcnt(0)
  v_mfma_f32_32x32x16_bf16 v[128:143], v[32:35], v[48:51], v[128:143]
  ds_read_b64_tr_b16 v[40:41], v2 offset:20480
  ds_read_b64_tr_b16 v[42:43], v2 offset:21504
  v_lshlrev_b32 v20, 16, v32
  v_and_b32 v21, s85, v32
  v_add_f32 v16, v16, v20
  v_mfma_f32_32x32x16_bf16 v[192:207], v[36:39], v[48:51], v[192:207]
  ds_read_b128 v[64:67], v6 offset:0
  ds_read_b64_tr_b16 v[44:45], v2 offset:28672
  v_add_f32 v17, v17, v21
  v_lshlrev_b32 v22, 16, v33
  v_and_b32 v23, s85, v33
  v_mfma_f32_32x32x16_bf16 v[144:159], v[32:35], v[52:55], v[144:159]
  ds_read_b64_tr_b16 v[46:47], v2 offset:29696
  ds_read_b128 v[68:71], v6 offset:4096
  v_add_f32 v16, v16, v22
  v_add_f32 v17, v17, v23
  v_lshlrev_b32 v24, 16, v34
  v_mfma_f32_32x32x16_bf16 v[208:223], v[36:39], v[52:55], v[208:223]
  ds_read_b128 v[72:75], v6 offset:8192
  ds_read_b128 v[76:79], v6 offset:12288
  v_and_b32 v25, s85, v34
  v_add_f32 v16, v16, v24
  v_add_f32 v17, v17, v25
  v_mfma_f32_32x32x16_bf16 v[160:175], v[32:35], v[56:59], v[160:175]
  v_lshlrev_b32 v26, 16, v35
  v_and_b32 v27, s85, v35
  v_add_f32 v16, v16, v26
  v_add_f32 v17, v17, v27
  v_lshlrev_b32 v20, 16, v36
  v_and_b32 v21, s85, v36
  v_mfma_f32_32x32x16_bf16 v[224:239], v[36:39], v[56:59], v[224:239]
  v_add_f32 v18, v18, v20
  v_add_f32 v19, v19, v21
  v_lshlrev_b32 v22, 16, v37
  v_and_b32 v23, s85, v37
  v_add_f32 v18, v18, v22
  v_add_f32 v19, v19, v23
  v_mfma_f32_32x32x16_bf16 v[176:191], v[32:35], v[60:63], v[176:191]
  v_lshlrev_b32 v24, 16, v38
  v_and_b32 v25, s85, v38
  v_add_f32 v18, v18, v24
  v_add_f32 v19, v19, v25
  v_lshlrev_b32 v26, 16, v39
  v_and_b32 v27, s85, v39
  v_mfma_f32_32x32x16_bf16 v[240:255], v[36:39], v[60:63], v[240:255]
  v_add_f32 v18, v18, v26
  v_add_f32 v19, v19, v27
  s_waitcnt lgkmcnt(0)
  v_mfma_f32_32x32x16_bf16 v[128:143], v[40:43], v[64:67], v[128:143]
  s_mov_b64 exec, 1
  ds_add_u32 v7, v30 offset:56
  s_mov_b64 exec, -1
  v_lshlrev_b32 v20, 16, v40
  v_and_b32 v21, s85, v40
  v_add_f32 v16, v16, v20
  v_add_f32 v17, v17, v21
  v_lshlrev_b32 v22, 16, v41
  v_mfma_f32_32x32x16_bf16 v[192:207], v[44:47], v[64:67], v[192:207]
  v_and_b32 v23, s85, v41
  v_add_f32 v16, v16, v22
  v_add_f32 v17, v17, v23
  v_lshlrev_b32 v24, 16, v42
  v_and_b32 v25, s85, v42
  v_mfma_f32_32x32x16_bf16 v[144:159], v[40:43], v[68:71], v[144:159]
  v_add_f32 v16, v16, v24
  v_add_f32 v17, v17, v25
  v_lshlrev_b32 v26, 16, v43
  v_and_b32 v27, s85, v43
  v_add_f32 v16, v16, v26
  v_mfma_f32_32x32x16_bf16 v[208:223], v[44:47], v[68:71], v[208:223]
  v_add_f32 v17, v17, v27
  v_lshlrev_b32 v20, 16, v44
  v_and_b32 v21, s85, v44
  v_add_f32 v18, v18, v20
  v_add_f32 v19, v19, v21
  v_mfma_f32_32x32x16_bf16 v[160:175], v[40:43], v[72:75], v[160:175]
  v_lshlrev_b32 v22, 16, v45
  v_and_b32 v23, s85, v45
  v_add_f32 v18, v18, v22
  v_add_f32 v19, v19, v23
  v_lshlrev_b32 v24, 16, v46
  v_mfma_f32_32x32x16_bf16 v[224:239], v[44:47], v[72:75], v[224:239]
  v_and_b32 v25, s85, v46
  v_add_f32 v18, v18, v24
  v_add_f32 v19, v19, v25
  v_lshlrev_b32 v26, 16, v47
  v_and_b32 v27, s85, v47
  v_mfma_f32_32x32x16_bf16 v[176:191], v[40:43], v[76:79], v[176:191]
  v_add_f32 v18, v18, v26
  v_add_f32 v19, v19, v27
  v_mfma_f32_32x32x16_bf16 v[240:255], v[44:47], v[76:79], v[240:255]
  v_add_f32 v16, v16, v17
  v_cvt_pk_bf16_f32 v20, v16, v16
  v_and_b32 v20, s85, v20
  v_sub_f32 v20, v16, v20
  v_cvt_pk_bf16_f32 v100, v16, v20
  v_add_f32 v18, v18, v19
  v_cvt_pk_bf16_f32 v21, v18, v18
  v_and_b32 v21, s85, v21
  v_sub_f32 v21, v18, v21
  v_cvt_pk_bf16_f32 v104, v18, v21
  s_waitcnt vmcnt(0)
gu_m_chk:
  v_max_u32 v20, v84, v88
  v_max_u32 v21, v92, v96
  v_max_u32 v20, v20, v21
  v_cmp_eq_u32 vcc, -1, v20
  s_nop 1
  s_cbranch_vccnz gu_m_stub
gu_m_ok:
  v_mfma_f32_32x32x16_bf16 v[128:143], v[100:103], v[84:87], v[128:143]
  v_mfma_f32_32x32x16_bf16 v[192:207], v[104:107], v[84:87], v[192:207]
  v_mfma_f32_32x32x16_bf16 v[144:159], v[100:103], v[88:91], v[144:159]
  v_mfma_f32_32x32x16_bf16 v[208:223], v[104:107], v[88:91], v[208:223]
  v_mfma_f32_32x32x16_bf16 v[160:175], v[100:103], v[92:95], v[160:175]
  v_mfma_f32_32x32x16_bf16 v[224:239], v[104:107], v[92:95], v[224:239]
  v_mfma_f32_32x32x16_bf16 v[176:191], v[100:103], v[96:99], v[176:191]
  v_mfma_f32_32x32x16_bf16 v[240:255], v[104:107], v[96:99], v[240:255]
  s_nop 4
  v_max_f32 v128, 0, v128
  v_max_f32 v129, 0, v129
  v_mul_f32 v128, v128, v192
  v_mul_f32 v129, v129, v193
  v_cvt_pk_bf16_f32 v32, v128, v129
  v_max_f32 v130, 0, v130
  v_max_f32 v131, 0, v131
  v_mul_f32 v130, v130, v194
  v_mul_f32 v131, v131, v195
  v_cvt_pk_bf16_f32 v33, v130, v131
  v_max_f32 v132, 0, v132
  v_max_f32 v133, 0, v133
  v_mul_f32 v132, v132, v196
  v_mul_f32 v133, v133, v197
  v_cvt_pk_bf16_f32 v34, v132, v133
  v_max_f32 v134, 0, v134
  v_max_f32 v135, 0, v135
  v_mul_f32 v134, v134, v198
  v_mul_f32 v135, v135, v199
  v_cvt_pk_bf16_f32 v35, v134, v135
  buffer_store_dwordx4 v[32:35], v1, s[28:31], s65 offen offset:0 sc0 sc1
  v_max_f32 v136, 0, v136
  v_max_f32 v137, 0, v137
  v_mul_f32 v136, v136, v200
  v_mul_f32 v137, v137, v201
  v_cvt_pk_bf16_f32 v36, v136, v137
  v_max_f32 v138, 0, v138
  v_max_f32 v139, 0, v139
  v_mul_f32 v138, v138, v202
  v_mul_f32 v139, v139, v203
  v_cvt_pk_bf16_f32 v37, v138, v139
  v_max_f32 v140, 0, v140
  v_max_f32 v141, 0, v141
  v_mul_f32 v140, v140, v204
  v_mul_f32 v141, v141, v205
  v_cvt_pk_bf16_f32 v38, v140, v141
  v_max_f32 v142, 0, v142
  v_max_f32 v143, 0, v143
  v_mul_f32 v142, v142, v206
  v_mul_f32 v143, v143, v207
  v_cvt_pk_bf16_f32 v39, v142, v143
  buffer_store_dwordx4 v[36:39], v1, s[28:31], s65 offen offset:1024 sc0 sc1
  v_max_f32 v144, 0, v144
  v_max_f32 v145, 0, v145
  v_mul_f32 v144, v144, v208
  v_mul_f32 v145, v145, v209
  v_cvt_pk_bf16_f32 v40, v144, v145
  v_max_f32 v146, 0, v146
  v_max_f32 v147, 0, v147
  v_mul_f32 v146, v146, v210
  v_mul_f32 v147, v147, v211
  v_cvt_pk_bf16_f32 v41, v146, v147
  v_max_f32 v148, 0, v148
  v_max_f32 v149, 0, v149
  v_mul_f32 v148, v148, v212
  v_mul_f32 v149, v149, v213
  v_cvt_pk_bf16_f32 v42, v148, v149
  v_max_f32 v150, 0, v150
  v_max_f32 v151, 0, v151
  v_mul_f32 v150, v150, v214
  v_mul_f32 v151, v151, v215
  v_cvt_pk_bf16_f32 v43, v150, v151
  buffer_store_dwordx4 v[40:43], v1, s[28:31], s66 offen offset:0 sc0 sc1
  v_max_f32 v152, 0, v152
  v_max_f32 v153, 0, v153
  v_mul_f32 v152, v152, v216
  v_mul_f32 v153, v153, v217
  v_cvt_pk_bf16_f32 v44, v152, v153
  v_max_f32 v154, 0, v154
  v_max_f32 v155, 0, v155
  v_mul_f32 v154, v154, v218
  v_mul_f32 v155, v155, v219
  v_cvt_pk_bf16_f32 v45, v154, v155
  v_max_f32 v156, 0, v156
  v_max_f32 v157, 0, v157
  v_mul_f32 v156, v156, v220
  v_mul_f32 v157, v157, v221
  v_cvt_pk_bf16_f32 v46, v156, v157
  v_max_f32 v158, 0, v158
  v_max_f32 v159, 0, v159
  v_mul_f32 v158, v158, v222
  v_mul_f32 v159, v159, v223
  v_cvt_pk_bf16_f32 v47, v158, v159
  buffer_store_dwordx4 v[44:47], v1, s[28:31], s66 offen offset:1024 sc0 sc1
  v_max_f32 v160, 0, v160
  v_max_f32 v161, 0, v161
  v_mul_f32 v160, v160, v224
  v_mul_f32 v161, v161, v225
  v_cvt_pk_bf16_f32 v48, v160, v161
  v_max_f32 v162, 0, v162
  v_max_f32 v163, 0, v163
  v_mul_f32 v162, v162, v226
  v_mul_f32 v163, v163, v227
  v_cvt_pk_bf16_f32 v49, v162, v163
  v_max_f32 v164, 0, v164
  v_max_f32 v165, 0, v165
  v_mul_f32 v164, v164, v228
  v_mul_f32 v165, v165, v229
  v_cvt_pk_bf16_f32 v50, v164, v165
  v_max_f32 v166, 0, v166
  v_max_f32 v167, 0, v167
  v_mul_f32 v166, v166, v230
  v_mul_f32 v167, v167, v231
  v_cvt_pk_bf16_f32 v51, v166, v167
  buffer_store_dwordx4 v[48:51], v1, s[28:31], s67 offen offset:0 sc0 sc1
  v_max_f32 v168, 0, v168
  v_max_f32 v169, 0, v169
  v_mul_f32 v168, v168, v232
  v_mul_f32 v169, v169, v233
  v_cvt_pk_bf16_f32 v52, v168, v169
  v_max_f32 v170, 0, v170
  v_max_f32 v171, 0, v171
  v_mul_f32 v170, v170, v234
  v_mul_f32 v171, v171, v235
  v_cvt_pk_bf16_f32 v53, v170, v171
  v_max_f32 v172, 0, v172
  v_max_f32 v173, 0, v173
  v_mul_f32 v172, v172, v236
  v_mul_f32 v173, v173, v237
  v_cvt_pk_bf16_f32 v54, v172, v173
  v_max_f32 v174, 0, v174
  v_max_f32 v175, 0, v175
  v_mul_f32 v174, v174, v238
  v_mul_f32 v175, v175, v239
  v_cvt_pk_bf16_f32 v55, v174, v175
  buffer_store_dwordx4 v[52:55], v1, s[28:31], s67 offen offset:1024 sc0 sc1
  v_max_f32 v176, 0, v176
  v_max_f32 v177, 0, v177
  v_mul_f32 v176, v176, v240
  v_mul_f32 v177, v177, v241
  v_cvt_pk_bf16_f32 v56, v176, v177
  v_max_f32 v178, 0, v178
  v_max_f32 v179, 0, v179
  v_mul_f32 v178, v178, v242
  v_mul_f32 v179, v179, v243
  v_cvt_pk_bf16_f32 v57, v178, v179
  v_max_f32 v180, 0, v180
  v_max_f32 v181, 0, v181
  v_mul_f32 v180, v180, v244
  v_mul_f32 v181, v181, v245
  v_cvt_pk_bf16_f32 v58, v180, v181
  v_max_f32 v182, 0, v182
  v_max_f32 v183, 0, v183
  v_mul_f32 v182, v182, v246
  v_mul_f32 v183, v183, v247
  v_cvt_pk_bf16_f32 v59, v182, v183
  buffer_store_dwordx4 v[56:59], v1, s[28:31], s68 offen offset:0 sc0 sc1
  v_max_f32 v184, 0, v184
  v_max_f32 v185, 0, v185
  v_mul_f32 v184, v184, v248
  v_mul_f32 v185, v185, v249
  v_cvt_pk_bf16_f32 v60, v184, v185
  v_max_f32 v186, 0, v186
  v_max_f32 v187, 0, v187
  v_mul_f32 v186, v186, v250
  v_mul_f32 v187, v187, v251
  v_cvt_pk_bf16_f32 v61, v186, v187
  v_max_f32 v188, 0, v188
  v_max_f32 v189, 0, v189
  v_mul_f32 v188, v188, v252
  v_mul_f32 v189, v189, v253
  v_cvt_pk_bf16_f32 v62, v188, v189
  v_max_f32 v190, 0, v190
  v_max_f32 v191, 0, v191
  v_mul_f32 v190, v190, v254
  v_mul_f32 v191, v191, v255
  v_cvt_pk_bf16_f32 v63, v190, v191
  buffer_store_dwordx4 v[60:63], v1, s[28:31], s68 offen offset:1024 sc0 sc1
  v_add_u32 v28, s71, v31
  s_lshl_b32 s65, s64, 2
  s_add_u32 s65, s65, 155712
  v_mov_b32 v4, s65
  s_mov_b32 s77, 400000
gu_sp:
  ds_read_b32 v5, v4
  s_waitcnt lgkmcnt(0)
  v_readfirstlane_b32 s65, v5
  s_sub_u32 s77, s77, 1
  s_cbranch_scc1 gu_spok
  s_cmp_eq_u32 s65, 0
  s_cbranch_scc1 gu_sp
gu_spok:
  s_branch gemm2
gu_m_stub:
  s_cmp_eq_u32 s79, 0
  s_cbranch_scc1 gu_m_ok
  s_sub_u32 s79, s79, 1
  s_sleep 6
  buffer_load_dword v84, v14, s[52:55], s70 offen offset:0 sc1
  buffer_load_dword v88, v14, s[52:55], s70 offen offset:128 sc1
  buffer_load_dword v92, v14, s[52:55], s70 offen offset:256 sc1
  buffer_load_dword v96, v14, s[52:55], s70 offen offset:384 sc1
  s_waitcnt vmcnt(0)
  s_branch gu_m_chk
gu_fla:
  s_waitcnt vmcnt(2)
  s_mov_b32 s77, 20000
gua_l1:
  v_readfirstlane_b32 s80, v28
  s_cmp_eq_u32 s80, 32
  s_cbranch_scc1 gua_l1ok
  s_sub_u32 s77, s77, 1
  s_cbranch_scc1 gua_l1ok
  s_sleep 8
  buffer_load_dword v28, v31, s[40:43], 0 offen sc1
  s_waitcnt vmcnt(0)
  s_branch gua_l1
gua_l1ok:
  s_branch gu_fla_ret
gu_helper:
  s_and_b32 s66, s64, 1
  s_lshl_b32 s66, s66, 2
  s_add_u32 s66, s66, s65
  s_lshr_b32 s67, s64, 1
  s_add_u32 s66, s66, s67
  s_mul_i32 s82, s66, 14336
  s_add_u32 s83, s82, 28672
  s_mul_i32 s84, s64, 28672
  s_lshl_b32 s86, s64, 11
  s_lshl_b32 s87, s64, 12
  s_add_u32 s78, s78, 128
  s_cmp_eq_u32 s78, 896
  s_cselect_b32 s78, 0, s78
  s_mul_i32 s85, s78, 1792
  s_add_u32 s85, s85, s84
  s_add_u32 s73, s82, s78
  s_add_u32 m0, s87, 49152
  s_nop 0
  buffer_load_dwordx4 v12, s[24:27], s73 offen lds
  s_add_u32 m0, s87, 50176
  s_nop 0
  buffer_load_dwordx4 v13, s[24:27], s73 offen lds
  s_add_u32 s73, s83, s78
  s_add_u32 m0, s87, 51200
  s_nop 0
  buffer_load_dwordx4 v12, s[24:27], s73 offen lds
  s_add_u32 m0, s87, 52224
  s_nop 0
  buffer_load_dwordx4 v13, s[24:27], s73 offen lds
  s_add_u32 s73, s85, 0
  s_add_u32 m0, s86, 65536
  s_nop 0
  buffer_load_dwordx4 v11, s[28:31], s73 offen lds
  s_add_u32 m0, s86, 73728
  s_nop 0
  buffer_load_dwordx4 v11, s[32:35], s73 offen lds
  s_add_u32 s73, s85, 14336
  s_add_u32 m0, s86, 66560
  s_nop 0
  buffer_load_dwordx4 v11, s[28:31], s73 offen lds
  s_add_u32 m0, s86, 74752
  s_nop 0
  buffer_load_dwordx4 v11, s[32:35], s73 offen lds
  s_mov_b32 s36, s16
  s_mov_b32 s37, s17
  s_mov_b32 s38, 1605632
  s_mov_b32 s39, 0x00020000
  v_lshrrev_b32 v5, 3, v0
  v_bfe_u32 v6, v0, 4, 1
  v_lshlrev_b32 v6, 2, v6
  v_and_b32 v29, 7, v0
  v_xor_b32 v6, v6, v29
  v_mul_u32_u24 v29, 896, v5
  v_lshl_add_u32 v29, v6, 4, v29
  s_mul_i32 s74, s64, 200704
  s_lshl_b32 s75, s61, 7
  s_add_u32 s74, s74, s75
  s_add_u32 s75, s74, 802816
  v_lshlrev_b32 v30, 2, v0
  v_add_u32 v30, 155648, v30
  v_mov_b32 v31, 0
  ds_write_b32 v30, v31
  v_and_b32 v22, 15, v0
  v_lshrrev_b32 v21, 4, v0
  s_lshl_b32 s67, s64, 4
  v_add_u32 v20, s67, v22
  v_cvt_f32_u32 v20, v20
  v_lshlrev_b32 v21, 2, v21
  v_cvt_f32_u32 v21, v21
  v_cvt_f32_u32 v22, v22
  v_mul_f32 v23, 0x3c800000, v20
  v_mul_f32 v24, v23, v21
  v_mul_f32 v25, 0x41400000, v23
  v_cos_f32 v26, v24
  v_sin_f32 v27, v24
  v_add_f32 v24, v24, v23
  v_cvt_pk_bf16_f32 v128, v26, v27
  v_cvt_pk_bf16_f32 v144, -v27, v26
  v_cos_f32 v26, v24
  v_sin_f32 v27, v24
  v_add_f32 v24, v24, v23
  v_cvt_pk_bf16_f32 v129, v26, v27
  v_cvt_pk_bf16_f32 v145, -v27, v26
  v_cos_f32 v26, v24
  v_sin_f32 v27, v24
  v_add_f32 v24, v24, v23
  v_cvt_pk_bf16_f32 v130, v26, v27
  v_cvt_pk_bf16_f32 v146, -v27, v26
  v_cos_f32 v26, v24
  v_sin_f32 v27, v24
  v_add_f32 v24, v24, v23
  v_cvt_pk_bf16_f32 v131, v26, v27
  v_cvt_pk_bf16_f32 v147, -v27, v26
  v_add_f32 v24, v24, v25
  v_cos_f32 v26, v24
  v_sin_f32 v27, v24
  v_add_f32 v24, v24, v23
  v_cvt_pk_bf16_f32 v132, v26, v27
  v_cvt_pk_bf16_f32 v148, -v27, v26
  v_cos_f32 v26, v24
  v_sin_f32 v27, v24
  v_add_f32 v24, v24, v23
  s_waitcnt lgkmcnt(0) vmcnt(10)
  s_barrier
  s_add_u32 s73, s85, 114688
  s_add_u32 m0, s86, 81920
  s_nop 0
  buffer_load_dwordx4 v11, s[28:31], s73 offen lds
  s_add_u32 m0, s86, 90112
  s_nop 0
  buffer_load_dwordx4 v11, s[32:35], s73 offen lds
  s_add_u32 s73, s85, 129024
  s_add_u32 m0, s86, 82944
  s_nop 0
  buffer_load_dwordx4 v11, s[28:31], s73 offen lds
  s_add_u32 m0, s86, 91136
  s_nop 0
  buffer_load_dwordx4 v11, s[32:35], s73 offen lds
  s_add_u32 s78, s78, 128
  s_cmp_eq_u32 s78, 896
  s_cselect_b32 s78, 0, s78
  s_mul_i32 s85, s78, 1792
  s_add_u32 s85, s85, s84
  s_add_u32 s73, s82, s78
  s_add_u32 m0, s87, 98304
  s_nop 0
  buffer_load_dwordx4 v12, s[24:27], s73 offen lds
  s_add_u32 m0, s87, 99328
  s_nop 0
  buffer_load_dwordx4 v13, s[24:27], s73 offen lds
  s_add_u32 s73, s83, s78
  s_add_u32 m0, s87, 100352
  s_nop 0
  buffer_load_dwordx4 v12, s[24:27], s73 offen lds
  s_add_u32 m0, s87, 101376
  s_nop 0
  buffer_load_dwordx4 v13, s[24:27], s73 offen lds
  v_cvt_pk_bf16_f32 v133, v26, v27
  v_cvt_pk_bf16_f32 v149, -v27, v26
  v_cos_f32 v26, v24
  v_sin_f32 v27, v24
  v_add_f32 v24, v24, v23
  v_cvt_pk_bf16_f32 v134, v26, v27
  v_cvt_pk_bf16_f32 v150, -v27, v26
  v_cos_f32 v26, v24
  v_sin_f32 v27, v24
  v_add_f32 v24, v24, v23
  v_cvt_pk_bf16_f32 v135, v26, v27
  v_cvt_pk_bf16_f32 v151, -v27, v26
  v_add_f32 v24, v24, v25
  v_cos_f32 v26, v24
  v_sin_f32 v27, v24
  v_add_f32 v24, v24, v23
  v_cvt_pk_bf16_f32 v136, v26, v27
  v_cvt_pk_bf16_f32 v152, -v27, v26
  v_cos_f32 v26, v24
  v_sin_f32 v27, v24
  v_add_f32 v24, v24, v23
  v_cvt_pk_bf16_f32 v137, v26, v27
  v_cvt_pk_bf16_f32 v153, -v27, v26
  v_cos_f32 v26, v24
  v_sin_f32 v27, v24
  v_add_f32 v24, v24, v23
  v_cvt_pk_bf16_f32 v138, v26, v27
  v_cvt_pk_bf16_f32 v154, -v27, v26
  s_waitcnt lgkmcnt(0) vmcnt(16)
  s_barrier
  s_add_u32 s73, s85, 0
  s_add_u32 m0, s86, 114688
  s_nop 0
  buffer_load_dwordx4 v11, s[28:31], s73 offen lds
  s_add_u32 m0, s86, 122880
  s_nop 0
  buffer_load_dwordx4 v11, s[32:35], s73 offen lds
  s_add_u32 s73, s85, 14336
  s_add_u32 m0, s86, 115712
  s_nop 0
  buffer_load_dwordx4 v11, s[28:31], s73 offen lds
  s_add_u32 m0, s86, 123904
  s_nop 0
  buffer_load_dwordx4 v11, s[32:35], s73 offen lds
  s_add_u32 s73, s85, 114688
  s_add_u32 m0, s86, 131072
  s_nop 0
  buffer_load_dwordx4 v11, s[28:31], s73 offen lds
  s_add_u32 m0, s86, 139264
  s_nop 0
  buffer_load_dwordx4 v11, s[32:35], s73 offen lds
  s_add_u32 s73, s85, 129024
  s_add_u32 m0, s86, 132096
  s_nop 0
  buffer_load_dwordx4 v11, s[28:31], s73 offen lds
  s_add_u32 m0, s86, 140288
  s_nop 0
  buffer_load_dwordx4 v11, s[32:35], s73 offen lds
  v_cos_f32 v26, v24
  v_sin_f32 v27, v24
  v_add_f32 v24, v24, v23
  v_cvt_pk_bf16_f32 v139, v26, v27
  v_cvt_pk_bf16_f32 v155, -v27, v26
  v_add_f32 v24, v24, v25
  v_cos_f32 v26, v24
  v_sin_f32 v27, v24
  v_add_f32 v24, v24, v23
  v_cvt_pk_bf16_f32 v140, v26, v27
  v_cvt_pk_bf16_f32 v156, -v27, v26
  v_cos_f32 v26, v24
  v_sin_f32 v27, v24
  v_add_f32 v24, v24, v23
  v_cvt_pk_bf16_f32 v141, v26, v27
  v_cvt_pk_bf16_f32 v157, -v27, v26
  v_cos_f32 v26, v24
  v_sin_f32 v27, v24
  v_add_f32 v24, v24, v23
  v_cvt_pk_bf16_f32 v142, v26, v27
  v_cvt_pk_bf16_f32 v158, -v27, v26
  v_cos_f32 v26, v24
  v_sin_f32 v27, v24
  v_add_f32 v24, v24, v23
  v_cvt_pk_bf16_f32 v143, v26, v27
  v_cvt_pk_bf16_f32 v159, -v27, v26
  v_add_f32 v23, 0x00000000, v22
  v_mul_f32 v23, 0x3d000000, v23
  s_waitcnt lgkmcnt(0) vmcnt(16)
  s_barrier
  s_add_u32 s78, s78, 128
  s_cmp_eq_u32 s78, 896
  s_cselect_b32 s78, 0, s78
  s_mul_i32 s85, s78, 1792
  s_add_u32 s85, s85, s84
  s_add_u32 s73, s82, s78
  s_add_u32 m0, s87, 16384
  s_nop 0
  buffer_load_dwordx4 v12, s[24:27], s73 offen lds
  s_add_u32 m0, s87, 17408
  s_nop 0
  buffer_load_dwordx4 v13, s[24:27], s73 offen lds
  s_add_u32 s73, s83, s78
  s_add_u32 m0, s87, 18432
  s_nop 0
  buffer_load_dwordx4 v12, s[24:27], s73 offen lds
  s_add_u32 m0, s87, 19456
  s_nop 0
  buffer_load_dwordx4 v13, s[24:27], s73 offen lds
  s_add_u32 s73, s85, 0
  s_add_u32 m0, s86, 32768
  s_nop 0
  buffer_load_dwordx4 v11, s[28:31], s73 offen lds
  s_add_u32 m0, s86, 40960
  s_nop 0
  buffer_load_dwordx4 v11, s[32:35], s73 offen lds
  s_add_u32 s73, s85, 14336
  s_add_u32 m0, s86, 33792
  s_nop 0
  buffer_load_dwordx4 v11, s[28:31], s73 offen lds
  s_add_u32 m0, s86, 41984
  s_nop 0
  buffer_load_dwordx4 v11, s[32:35], s73 offen lds
  v_mul_f32 v24, v23, v21
  v_mul_f32 v25, 0x41400000, v23
  v_cos_f32 v26, v24
  v_sin_f32 v27, v24
  v_add_f32 v24, v24, v23
  v_cvt_pk_bf16_f32 v160, v26, v27
  v_cvt_pk_bf16_f32 v176, -v27, v26
  v_cos_f32 v26, v24
  v_sin_f32 v27, v24
  v_add_f32 v24, v24, v23
  v_cvt_pk_bf16_f32 v161, v26, v27
  v_cvt_pk_bf16_f32 v177, -v27, v26
  v_cos_f32 v26, v24
  v_sin_f32 v27, v24
  v_add_f32 v24, v24, v23
  v_cvt_pk_bf16_f32 v162, v26, v27
  v_cvt_pk_bf16_f32 v178, -v27, v26
  v_cos_f32 v26, v24
  v_sin_f32 v27, v24
  v_add_f32 v24, v24, v23
  v_cvt_pk_bf16_f32 v163, v26, v27
  v_cvt_pk_bf16_f32 v179, -v27, v26
  v_add_f32 v24, v24, v25
  v_cos_f32 v26, v24
  v_sin_f32 v27, v24
  v_add_f32 v24, v24, v23
  v_cvt_pk_bf16_f32 v164, v26, v27
  v_cvt_pk_bf16_f32 v180, -v27, v26
  s_waitcnt lgkmcnt(0) vmcnt(20)
  s_barrier
  s_add_u32 s73, s85, 114688
  s_add_u32 m0, s86, 0
  s_nop 0
  buffer_load_dwordx4 v11, s[28:31], s73 offen lds
  s_add_u32 m0, s86, 8192
  s_nop 0
  buffer_load_dwordx4 v11, s[32:35], s73 offen lds
  s_add_u32 s73, s85, 129024
  s_add_u32 m0, s86, 1024
  s_nop 0
  buffer_load_dwordx4 v11, s[28:31], s73 offen lds
  s_add_u32 m0, s86, 9216
  s_nop 0
  buffer_load_dwordx4 v11, s[32:35], s73 offen lds
  s_add_u32 s78, s78, 128
  s_cmp_eq_u32 s78, 896
  s_cselect_b32 s78, 0, s78
  s_mul_i32 s85, s78, 1792
  s_add_u32 s85, s85, s84
  s_add_u32 s73, s82, s78
  s_add_u32 m0, s87, 65536
  s_nop 0
  buffer_load_dwordx4 v12, s[24:27], s73 offen lds
  s_add_u32 m0, s87, 66560
  s_nop 0
  buffer_load_dwordx4 v13, s[24:27], s73 offen lds
  s_add_u32 s73, s83, s78
  s_add_u32 m0, s87, 67584
  s_nop 0
  buffer_load_dwordx4 v12, s[24:27], s73 offen lds
  s_add_u32 m0, s87, 68608
  s_nop 0
  buffer_load_dwordx4 v13, s[24:27], s73 offen lds
  v_cos_f32 v26, v24
  v_sin_f32 v27, v24
  v_add_f32 v24, v24, v23
  v_cvt_pk_bf16_f32 v165, v26, v27
  v_cvt_pk_bf16_f32 v181, -v27, v26
  v_cos_f32 v26, v24
  v_sin_f32 v27, v24
  v_add_f32 v24, v24, v23
  v_cvt_pk_bf16_f32 v166, v26, v27
  v_cvt_pk_bf16_f32 v182, -v27, v26
  v_cos_f32 v26, v24
  v_sin_f32 v27, v24
  v_add_f32 v24, v24, v23
  v_cvt_pk_bf16_f32 v167, v26, v27
  v_cvt_pk_bf16_f32 v183, -v27, v26
  v_add_f32 v23, 0x41800000, v22
  v_mul_f32 v23, 0x3d000000, v23
  v_mul_f32 v24, v23, v21
  v_mul_f32 v25, 0x41400000, v23
  v_cos_f32 v26, v24
  v_sin_f32 v27, v24
  v_add_f32 v24, v24, v23
  v_cvt_pk_bf16_f32 v168, v26, v27
  v_cvt_pk_bf16_f32 v184, -v27, v26
  v_cos_f32 v26, v24
  v_sin_f32 v27, v24
  v_add_f32 v24, v24, v23
  v_cvt_pk_bf16_f32 v169, v26, v27
  s_waitcnt lgkmcnt(0) vmcnt(20)
  s_barrier
  s_add_u32 s73, s85, 0
  s_add_u32 m0, s86, 81920
  s_nop 0
  buffer_load_dwordx4 v11, s[28:31], s73 offen lds
  s_add_u32 m0, s86, 90112
  s_nop 0
  buffer_load_dwordx4 v11, s[32:35], s73 offen lds
  s_add_u32 s73, s85, 14336
  s_add_u32 m0, s86, 82944
  s_nop 0
  buffer_load_dwordx4 v11, s[28:31], s73 offen lds
  s_add_u32 m0, s86, 91136
  s_nop 0
  buffer_load_dwordx4 v11, s[32:35], s73 offen lds
  s_add_u32 s73, s85, 114688
  s_add_u32 m0, s86, 49152
  s_nop 0
  buffer_load_dwordx4 v11, s[28:31], s73 offen lds
  s_add_u32 m0, s86, 57344
  s_nop 0
  buffer_load_dwordx4 v11, s[32:35], s73 offen lds
  s_add_u32 s73, s85, 129024
  s_add_u32 m0, s86, 50176
  s_nop 0
  buffer_load_dwordx4 v11, s[28:31], s73 offen lds
  s_add_u32 m0, s86, 58368
  s_nop 0
  buffer_load_dwordx4 v11, s[32:35], s73 offen lds
  v_cvt_pk_bf16_f32 v185, -v27, v26
  v_cos_f32 v26, v24
  v_sin_f32 v27, v24
  v_add_f32 v24, v24, v23
  v_cvt_pk_bf16_f32 v170, v26, v27
  v_cvt_pk_bf16_f32 v186, -v27, v26
  v_cos_f32 v26, v24
  v_sin_f32 v27, v24
  v_add_f32 v24, v24, v23
  v_cvt_pk_bf16_f32 v171, v26, v27
  v_cvt_pk_bf16_f32 v187, -v27, v26
  v_add_f32 v24, v24, v25
  v_cos_f32 v26, v24
  v_sin_f32 v27, v24
  v_add_f32 v24, v24, v23
  v_cvt_pk_bf16_f32 v172, v26, v27
  v_cvt_pk_bf16_f32 v188, -v27, v26
  v_cos_f32 v26, v24
  v_sin_f32 v27, v24
  v_add_f32 v24, v24, v23
  v_cvt_pk_bf16_f32 v173, v26, v27
  v_cvt_pk_bf16_f32 v189, -v27, v26
  v_cos_f32 v26, v24
  v_sin_f32 v27, v24
  v_add_f32 v24, v24, v23
  v_cvt_pk_bf16_f32 v174, v26, v27
  v_cvt_pk_bf16_f32 v190, -v27, v26
  v_cos_f32 v26, v24
  s_waitcnt lgkmcnt(0) vmcnt(24)
  s_barrier
  s_add_u32 s78, s78, 128
  s_cmp_eq_u32 s78, 896
  s_cselect_b32 s78, 0, s78
  s_mul_i32 s85, s78, 1792
  s_add_u32 s85, s85, s84
  s_add_u32 s73, s82, s78
  s_add_u32 m0, s87, 114688
  s_nop 0
  buffer_load_dwordx4 v12, s[24:27], s73 offen lds
  s_add_u32 m0, s87, 115712
  s_nop 0
  buffer_load_dwordx4 v13, s[24:27], s73 offen lds
  s_add_u32 s73, s83, s78
  s_add_u32 m0, s87, 116736
  s_nop 0
  buffer_load_dwordx4 v12, s[24:27], s73 offen lds
  s_add_u32 m0, s87, 117760
  s_nop 0
  buffer_load_dwordx4 v13, s[24:27], s73 offen lds
  v_sin_f32 v27, v24
  v_add_f32 v24, v24, v23
  v_cvt_pk_bf16_f32 v175, v26, v27
  v_cvt_pk_bf16_f32 v191, -v27, v26
  v_mul_f32 v23, 0x3a000000, v20
  v_mul_f32 v24, v23, v21
  v_mul_f32 v25, 0x41400000, v23
  v_cos_f32 v192, v24
  v_sin_f32 v193, v24
  v_add_f32 v24, v24, v23
  v_cos_f32 v194, v24
  v_sin_f32 v195, v24
  v_add_f32 v24, v24, v23
  v_cos_f32 v196, v24
  v_sin_f32 v197, v24
  v_add_f32 v24, v24, v23
  v_cos_f32 v198, v24
  v_sin_f32 v199, v24
  v_add_f32 v24, v24, v23
  v_add_f32 v24, v24, v25
  v_cos_f32 v200, v24
  v_sin_f32 v201, v24
  v_add_f32 v24, v24, v23
  v_cos_f32 v202, v24
  v_sin_f32 v203, v24
  v_add_f32 v24, v24, v23
  v_cos_f32 v204, v24
  v_sin_f32 v205, v24
  s_waitcnt lgkmcnt(0) vmcnt(20)
  s_barrier
  s_add_u32 s73, s85, 0
  s_add_u32 m0, s86, 131072
  s_nop 0
  buffer_load_dwordx4 v11, s[28:31], s73 offen lds
  s_add_u32 m0, s86, 139264
  s_nop 0
  buffer_load_dwordx4 v11, s[32:35], s73 offen lds
  s_add_u32 s73, s85, 14336
  s_add_u32 m0, s86, 132096
  s_nop 0
  buffer_load_dwordx4 v11, s[28:31], s73 offen lds
  s_add_u32 m0, s86, 140288
  s_nop 0
  buffer_load_dwordx4 v11, s[32:35], s73 offen lds
  s_add_u32 s73, s85, 114688
  s_add_u32 m0, s86, 98304
  s_nop 0
  buffer_load_dwordx4 v11, s[28:31], s73 offen lds
  s_add_u32 m0, s86, 106496
  s_nop 0
  buffer_load_dwordx4 v11, s[32:35], s73 offen lds
  s_add_u32 s73, s85, 129024
  s_add_u32 m0, s86, 99328
  s_nop 0
  buffer_load_dwordx4 v11, s[28:31], s73 offen lds
  s_add_u32 m0, s86, 107520
  s_nop 0
  buffer_load_dwordx4 v11, s[32:35], s73 offen lds
  v_add_f32 v24, v24, v23
  v_cos_f32 v206, v24
  v_sin_f32 v207, v24
  v_add_f32 v24, v24, v23
  v_cvt_f32_u32 v53, s67
  v_add_f32 v53, v53, v21
  v_add_f32 v23, 0x00000000, v22
  v_mul_f32 v23, 0x3a000000, v23
  v_mul_f32 v24, v23, v53
  v_cos_f32 v208, v24
  v_sin_f32 v209, v24
  v_add_f32 v24, v24, v23
  v_cos_f32 v210, v24
  v_sin_f32 v211, v24
  v_add_f32 v24, v24, v23
  v_cos_f32 v212, v24
  v_sin_f32 v213, v24
  v_add_f32 v24, v24, v23
  v_cos_f32 v214, v24
  v_sin_f32 v215, v24
  v_add_f32 v24, v24, v23
  v_add_f32 v23, 0x41800000, v22
  v_mul_f32 v23, 0x3a000000, v23
  v_mul_f32 v24, v23, v53
  v_cos_f32 v216, v24
  v_sin_f32 v217, v24
  v_add_f32 v24, v24, v23
  v_cos_f32 v218, v24
  s_waitcnt lgkmcnt(0) vmcnt(24)
  s_barrier
  s_add_u32 s78, s78, 128
  s_cmp_eq_u32 s78, 896
  s_cselect_b32 s78, 0, s78
  s_mul_i32 s85, s78, 1792
  s_add_u32 s85, s85, s84
  s_add_u32 s73, s82, s78
  s_add_u32 m0, s87, 32768
  s_nop 0
  buffer_load_dwordx4 v12, s[24:27], s73 offen lds
  s_add_u32 m0, s87, 33792
  s_nop 0
  buffer_load_dwordx4 v13, s[24:27], s73 offen lds
  s_add_u32 s73, s83, s78
  s_add_u32 m0, s87, 34816
  s_nop 0
  buffer_load_dwordx4 v12, s[24:27], s73 offen lds
  s_add_u32 m0, s87, 35840
  s_nop 0
  buffer_load_dwordx4 v13, s[24:27], s73 offen lds
  v_sin_f32 v219, v24
  v_add_f32 v24, v24, v23
  v_cos_f32 v220, v24
  v_sin_f32 v221, v24
  v_add_f32 v24, v24, v23
  v_cos_f32 v222, v24
  v_sin_f32 v223, v24
  v_add_f32 v24, v24, v23
  v_mul_f32 v208, 0x36124925, v208
  v_mul_f32 v209, 0x36124925, v209
  v_mul_f32 v210, 0x36124925, v210
  v_mul_f32 v211, 0x36124925, v211
  v_mul_f32 v212, 0x36124925, v212
  v_mul_f32 v213, 0x36124925, v213
  v_mul_f32 v214, 0x36124925, v214
  v_mul_f32 v215, 0x36124925, v215
  v_mul_f32 v216, 0x36124925, v216
  v_mul_f32 v217, 0x36124925, v217
  v_mul_f32 v218, 0x36124925, v218
  v_mul_f32 v219, 0x36124925, v219
  v_mul_f32 v220, 0x36124925, v220
  v_mul_f32 v221, 0x36124925, v221
  v_mul_f32 v222, 0x36124925, v222
  v_mul_f32 v223, 0x36124925, v223
  s_waitcnt lgkmcnt(0) vmcnt(20)
  s_barrier
  s_add_u32 s44, s22, 7405568
  s_addc_u32 s45, s23, 0
  s_mov_b32 s46, 1949696
  s_mov_b32 s47, 0x00020000
  s_add_u32 s48, s22, 9355264
  s_addc_u32 s49, s23, 0
  s_mov_b32 s50, 1909248
  s_mov_b32 s51, 0x00020000
  s_add_u32 s40, s22, 13181696
  s_addc_u32 s41, s23, 0
  s_mov_b32 s42, 65536
  s_mov_b32 s43, 0x00020000
  v_and_b32 v1, 15, v0
  v_lshrrev_b32 v2, 4, v0
  v_lshlrev_b32 v3, 4, v0
  s_mul_i32 s69, s62, 8704
  s_add_u32 s70, s69, 4096
  v_and_b32 v5, 1, v0
  v_lshlrev_b32 v5, 7, v5
  v_lshrrev_b32 v6, 1, v1
  v_lshl_add_u32 v5, v6, 4, v5
  v_lshl_add_u32 v5, v2, 10, v5
  v_lshlrev_b32 v6, 4, v1
  v_lshl_add_u32 v6, v2, 9, v6
  s_mul_i32 s71, s63, 8448
  s_lshl_b32 s72, s64, 8
  s_add_u32 s71, s71, s72
  s_add_u32 s71, s71, 8448
  s_add_u32 s72, s71, 4096
  s_and_b32 s65, s63, 63
  s_lshl_b32 s65, s65, 7
  v_mov_b32 v18, s65
  s_and_b32 s65, s63, 3
  s_lshl_b32 s65, s65, 7
  s_add_u32 s65, s65, 57344
  s_lshr_b32 s68, s63, 5
  s_lshl_b32 s68, s68, 9
  s_add_u32 s68, s68, s65
  v_writelane_b32 v18, s68, 1
  s_add_u32 s68, s63, 1
  s_lshr_b32 s68, s68, 5
  s_lshl_b32 s68, s68, 9
  s_add_u32 s68, s68, s65
  s_add_u32 s68, s68, 4096
  v_writelane_b32 v18, s68, 2
  s_lshl_b32 s65, s64, 13
  s_lshl_b32 s68, s63, 2
  s_add_u32 s65, s65, s68
  s_add_u32 s65, s65, 24576
  v_lshlrev_b32 v28, 10, v0
  v_add_u32 v28, s65, v28
  v_mov_b32 v19, 0x40000000
  v_cmp_gt_u32 vcc, 8, v0
  s_nop 1
  v_cndmask_b32 v28, v19, v28, vcc
  s_add_u32 s73, s85, 0
  s_add_u32 m0, s86, 0
  s_nop 0
  buffer_load_dwordx4 v11, s[28:31], s73 offen lds
  s_add_u32 m0, s86, 8192
  s_nop 0
  buffer_load_dwordx4 v11, s[32:35], s73 offen lds
  s_add_u32 s73, s85, 14336
  s_add_u32 m0, s86, 1024
  s_nop 0
  buffer_load_dwordx4 v11, s[28:31], s73 offen lds
  s_add_u32 m0, s86, 9216
  s_nop 0
  buffer_load_dwordx4 v11, s[32:35], s73 offen lds
  s_add_u32 s73, s85, 114688
  s_add_u32 m0, s86, 16384
  s_nop 0
  buffer_load_dwordx4 v11, s[28:31], s73 offen lds
  s_add_u32 m0, s86, 24576
  s_nop 0
  buffer_load_dwordx4 v11, s[32:35], s73 offen lds
  s_add_u32 s73, s85, 129024
  s_add_u32 m0, s86, 17408
  s_nop 0
  buffer_load_dwordx4 v11, s[28:31], s73 offen lds
  s_add_u32 m0, s86, 25600
  s_nop 0
  buffer_load_dwordx4 v11, s[32:35], s73 offen lds
  s_waitcnt lgkmcnt(0) vmcnt(24)
  s_barrier
  s_add_u32 s85, s61, 0
  s_cmp_ge_u32 s85, 7
  s_cselect_b32 s73, 7, 0
  s_sub_u32 s85, s85, s73
  s_mul_i32 s85, s85, 28672
  s_add_u32 s85, s85, s74
  s_add_u32 s73, s85, 0
  s_add_u32 m0, s87, 81920
  s_nop 0
  buffer_load_dwordx4 v29, s[36:39], s73 offen lds
  s_add_u32 s73, s85, 7168
  s_add_u32 m0, s87, 82944
  s_nop 0
  buffer_load_dwordx4 v29, s[36:39], s73 offen lds
  s_add_u32 s73, s85, 14336
  s_add_u32 m0, s87, 83968
  s_nop 0
  buffer_load_dwordx4 v29, s[36:39], s73 offen lds
  s_add_u32 s73, s85, 21504
  s_add_u32 m0, s87, 84992
  s_nop 0
  buffer_load_dwordx4 v29, s[36:39], s73 offen lds
  s_waitcnt lgkmcnt(0) vmcnt(20)
  s_barrier
  s_add_u32 s85, s61, 1
  s_cmp_ge_u32 s85, 7
  s_cselect_b32 s73, 7, 0
  s_sub_u32 s85, s85, s73
  s_mul_i32 s85, s85, 28672
  s_add_u32 s85, s85, s74
  s_add_u32 s73, s85, 0
  s_add_u32 m0, s87, 49152
  s_nop 0
  buffer_load_dwordx4 v29, s[36:39], s73 offen lds
  s_add_u32 s73, s85, 7168
  s_add_u32 m0, s87, 50176
  s_nop 0
  buffer_load_dwordx4 v29, s[36:39], s73 offen lds
  s_add_u32 s73, s85, 14336
  s_add_u32 m0, s87, 51200
  s_nop 0
  buffer_load_dwordx4 v29, s[36:39], s73 offen lds
  s_add_u32 s73, s85, 21504
  s_add_u32 m0, s87, 52224
  s_nop 0
  buffer_load_dwordx4 v29, s[36:39], s73 offen lds
  s_add_u32 s85, s61, 2
  s_cmp_ge_u32 s85, 7
  s_cselect_b32 s73, 7, 0
  s_sub_u32 s85, s85, s73
  s_mul_i32 s85, s85, 28672
  s_add_u32 s85, s85, s74
  s_add_u32 s73, s85, 0
  s_add_u32 m0, s87, 65536
  s_nop 0
  buffer_load_dwordx4 v29, s[36:39], s73 offen lds
  s_add_u32 s73, s85, 7168
  s_add_u32 m0, s87, 66560
  s_nop 0
  buffer_load_dwordx4 v29, s[36:39], s73 offen lds
  s_add_u32 s73, s85, 14336
  s_add_u32 m0, s87, 67584
  s_nop 0
  buffer_load_dwordx4 v29, s[36:39], s73 offen lds
  s_add_u32 s73, s85, 21504
  s_add_u32 m0, s87, 68608
  s_nop 0
  buffer_load_dwordx4 v29, s[36:39], s73 offen lds
  s_waitcnt lgkmcnt(0) vmcnt(12)
  s_barrier
  s_mov_b32 s76, 0
  v_mov_b32 v30, 155776
  ds_read_b32 v17, v30 offset:4
  s_add_u32 s85, s61, 3
  s_cmp_ge_u32 s85, 7
  s_cselect_b32 s73, 7, 0
  s_sub_u32 s85, s85, s73
  s_mul_i32 s85, s85, 28672
  s_add_u32 s85, s85, s74
  s_add_u32 s73, s85, 0
  s_add_u32 m0, s87, 131072
  s_nop 0
  buffer_load_dwordx4 v29, s[36:39], s73 offen lds
  s_add_u32 s73, s85, 7168
  s_add_u32 m0, s87, 132096
  s_nop 0
  buffer_load_dwordx4 v29, s[36:39], s73 offen lds
  s_add_u32 s73, s85, 14336
  s_add_u32 m0, s87, 133120
  s_nop 0
  buffer_load_dwordx4 v29, s[36:39], s73 offen lds
  s_add_u32 s73, s85, 21504
  s_add_u32 m0, s87, 134144
  s_nop 0
  buffer_load_dwordx4 v29, s[36:39], s73 offen lds
fft_body:
  s_lshl_b32 s65, s64, 2
  s_add_u32 s65, s65, 155712
  v_mov_b32 v8, s65
  v_mov_b32 v9, 1
  s_waitcnt lgkmcnt(0)
  v_readfirstlane_b32 s73, v17
  s_cmp_eq_u32 s73, 0
  s_cbranch_scc1 fd_slow
fd_go:
  buffer_load_dwordx4 v[32:35], v6, s[44:47], s69 offen offset:0
  buffer_load_dwordx4 v[48:51], v6, s[44:47], s69 offen offset:256
  buffer_load_dwordx4 v[36:39], v6, s[44:47], s69 offen offset:2048
  buffer_load_dwordx4 v[52:55], v6, s[44:47], s69 offen offset:2304
  buffer_load_dwordx4 v[40:43], v6, s[44:47], s70 offen offset:0
  buffer_load_dwordx4 v[56:59], v6, s[44:47], s70 offen offset:256
  buffer_load_dwordx4 v[44:47], v6, s[44:47], s70 offen offset:2048
  buffer_load_dwordx4 v[60:63], v6, s[44:47], s70 offen offset:2304
  buffer_load_dwordx4 v[64:67], v5, s[48:51], s71 offen
  buffer_load_dwordx4 v[68:71], v5, s[48:51], s72 offen
  s_waitcnt vmcnt(10)
  ds_write_b32 v8, v9
  s_cmp_eq_u32 s76, 0
  s_cbranch_scc1 hk12
hk12_ret:
  s_cmp_eq_u32 s76, 0
  s_cbranch_scc1 w2_x
  s_waitcnt vmcnt(0)
w2_x:
  s_waitcnt vmcnt(8)
  s_add_u32 s44, s22, 11264512
  s_addc_u32 s45, s23, 0
  s_mov_b32 s46, 1900800
  s_mov_b32 s47, 0x00020000
  s_cmp_lg_u32 s62, 0
  s_cbranch_scc1 fft_nofix
  s_cmp_eq_u32 s63, 224
  s_cselect_b32 s68, 16, 0
  v_lshrrev_b32 v32, s68, v32
  v_and_b32 v32, 0xffff, v32
  v_lshrrev_b32 v33, s68, v33
  v_and_b32 v33, 0xffff, v33
  v_lshrrev_b32 v34, s68, v34
  v_and_b32 v34, 0xffff, v34
  v_lshrrev_b32 v35, s68, v35
  v_and_b32 v35, 0xffff, v35
  v_lshrrev_b32 v36, s68, v36
  v_and_b32 v36, 0xffff, v36
  v_lshrrev_b32 v37, s68, v37
  v_and_b32 v37, 0xffff, v37
  v_lshrrev_b32 v38, s68, v38
  v_and_b32 v38, 0xffff, v38
  v_lshrrev_b32 v39, s68, v39
  v_and_b32 v39, 0xffff, v39
  v_lshrrev_b32 v40, s68, v40
  v_and_b32 v40, 0xffff, v40
  v_lshrrev_b32 v41, s68, v41
  v_and_b32 v41, 0xffff, v41
  v_lshrrev_b32 v42, s68, v42
  v_and_b32 v42, 0xffff, v42
  v_lshrrev_b32 v43, s68, v43
  v_and_b32 v43, 0xffff, v43
  v_lshrrev_b32 v44, s68, v44
  v_and_b32 v44, 0xffff, v44
  v_lshrrev_b32 v45, s68, v45
  v_and_b32 v45, 0xffff, v45
  v_lshrrev_b32 v46, s68, v46
  v_and_b32 v46, 0xffff, v46
  v_lshrrev_b32 v47, s68, v47
  v_and_b32 v47, 0xffff, v47
  v_lshrrev_b32 v48, s68, v48
  v_and_b32 v48, 0xffff, v48
  v_lshrrev_b32 v49, s68, v49
  v_and_b32 v49, 0xffff, v49
  v_lshrrev_b32 v50, s68, v50
  v_and_b32 v50, 0xffff, v50
  v_lshrrev_b32 v51, s68, v51
  v_and_b32 v51, 0xffff, v51
  v_lshrrev_b32 v52, s68, v52
  v_and_b32 v52, 0xffff, v52
  v_lshrrev_b32 v53, s68, v53
  v_and_b32 v53, 0xffff, v53
  v_lshrrev_b32 v54, s68, v54
  v_and_b32 v54, 0xffff, v54
  v_lshrrev_b32 v55, s68, v55
  v_and_b32 v55, 0xffff, v55
  v_lshrrev_b32 v56, s68, v56
  v_and_b32 v56, 0xffff, v56
  v_lshrrev_b32 v57, s68, v57
  v_and_b32 v57, 0xffff, v57
  v_lshrrev_b32 v58, s68, v58
  v_and_b32 v58, 0xffff, v58
  v_lshrrev_b32 v59, s68, v59
  v_and_b32 v59, 0xffff, v59
  v_lshrrev_b32 v60, s68, v60
  v_and_b32 v60, 0xffff, v60
  v_lshrrev_b32 v61, s68, v61
  v_and_b32 v61, 0xffff, v61
  v_lshrrev_b32 v62, s68, v62
  v_and_b32 v62, 0xffff, v62
  v_lshrrev_b32 v63, s68, v63
  v_and_b32 v63, 0xffff, v63
  s_nop 1
fft_nofix:
  v_mfma_f32_16x16x32_bf16 v[72:75], v[32:35], v[128:131], 0
  v_mfma_f32_16x16x32_bf16 v[80:83], v[32:35], v[144:147], 0
  v_mfma_f32_16x16x32_bf16 v[76:79], v[48:51], v[128:131], 0
  v_mfma_f32_16x16x32_bf16 v[84:87], v[48:51], v[144:147], 0
  v_mfma_f32_16x16x32_bf16 v[72:75], v[36:39], v[132:135], v[72:75]
  v_mfma_f32_16x16x32_bf16 v[80:83], v[36:39], v[148:151], v[80:83]
  v_mfma_f32_16x16x32_bf16 v[76:79], v[52:55], v[132:135], v[76:79]
  v_mfma_f32_16x16x32_bf16 v[84:87], v[52:55], v[148:151], v[84:87]
  v_mfma_f32_16x16x32_bf16 v[72:75], v[40:43], v[136:139], v[72:75]
  v_mfma_f32_16x16x32_bf16 v[80:83], v[40:43], v[152:155], v[80:83]
  v_mfma_f32_16x16x32_bf16 v[76:79], v[56:59], v[136:139], v[76:79]
  v_mfma_f32_16x16x32_bf16 v[84:87], v[56:59], v[152:155], v[84:87]
  v_mfma_f32_16x16x32_bf16 v[72:75], v[44:47], v[140:143], v[72:75]
  v_mfma_f32_16x16x32_bf16 v[80:83], v[44:47], v[156:159], v[80:83]
  v_mfma_f32_16x16x32_bf16 v[76:79], v[60:63], v[140:143], v[76:79]
  v_mfma_f32_16x16x32_bf16 v[84:87], v[60:63], v[156:159], v[84:87]
  s_nop 4
  v_mul_f32 v8, v72, v192
  v_mul_f32 v9, v80, v192
  v_fmac_f32 v8, v80, v193
  v_fma_f32 v9, -v72, v193, v9
  v_cvt_pk_bf16_f32 v104, v8, v9
  v_mul_f32 v10, v73, v194
  v_mul_f32 v11, v81, v194
  v_fmac_f32 v10, v81, v195
  v_fma_f32 v11, -v73, v195, v11
  v_cvt_pk_bf16_f32 v105, v10, v11
  v_mul_f32 v12, v74, v196
  v_mul_f32 v13, v82, v196
  v_fmac_f32 v12, v82, v197
  v_fma_f32 v13, -v74, v197, v13
  v_cvt_pk_bf16_f32 v106, v12, v13
  v_mul_f32 v14, v75, v198
  v_mul_f32 v15, v83, v198
  v_fmac_f32 v14, v83, v199
  v_fma_f32 v15, -v75, v199, v15
  v_cvt_pk_bf16_f32 v107, v14, v15
  v_mul_f32 v8, v76, v200
  v_mul_f32 v9, v84, v200
  v_fmac_f32 v8, v84, v201
  v_fma_f32 v9, -v76, v201, v9
  v_cvt_pk_bf16_f32 v108, v8, v9
  v_mul_f32 v10, v77, v202
  v_mul_f32 v11, v85, v202
  v_fmac_f32 v10, v85, v203
  v_fma_f32 v11, -v77, v203, v11
  v_cvt_pk_bf16_f32 v109, v10, v11
  v_mul_f32 v12, v78, v204
  v_mul_f32 v13, v86, v204
  v_fmac_f32 v12, v86, v205
  v_fma_f32 v13, -v78, v205, v13
  v_cvt_pk_bf16_f32 v110, v12, v13
  v_mul_f32 v14, v79, v206
  v_mul_f32 v15, v87, v206
  v_fmac_f32 v14, v87, v207
  v_fma_f32 v15, -v79, v207, v15
  v_cvt_pk_bf16_f32 v111, v14, v15
  v_mfma_f32_16x16x32_bf16 v[88:91], v[160:163], v[104:107], 0
  v_mfma_f32_16x16x32_bf16 v[96:99], v[176:179], v[104:107], 0
  v_mfma_f32_16x16x32_bf16 v[92:95], v[168:171], v[104:107], 0
  v_mfma_f32_16x16x32_bf16 v[100:103], v[184:187], v[104:107], 0
  v_mfma_f32_16x16x32_bf16 v[88:91], v[164:167], v[108:111], v[88:91]
  v_mfma_f32_16x16x32_bf16 v[96:99], v[180:183], v[108:111], v[96:99]
  v_mfma_f32_16x16x32_bf16 v[92:95], v[172:175], v[108:111], v[92:95]
  v_mfma_f32_16x16x32_bf16 v[100:103], v[188:191], v[108:111], v[100:103]
  v_lshlrev_b32 v112, 16, v64
  v_lshlrev_b32 v120, 16, v66
  v_and_b32 v113, 0xffff0000, v64
  v_and_b32 v121, 0xffff0000, v66
  v_lshlrev_b32 v114, 16, v65
  v_lshlrev_b32 v122, 16, v67
  v_and_b32 v115, 0xffff0000, v65
  v_and_b32 v123, 0xffff0000, v67
  v_lshlrev_b32 v116, 16, v68
  v_lshlrev_b32 v124, 16, v70
  v_and_b32 v117, 0xffff0000, v68
  v_and_b32 v125, 0xffff0000, v70
  v_lshlrev_b32 v118, 16, v69
  v_lshlrev_b32 v126, 16, v71
  v_and_b32 v119, 0xffff0000, v69
  v_and_b32 v127, 0xffff0000, v71
  v_mul_f32 v8, v88, v112
  v_mul_f32 v9, v88, v120
  v_fma_f32 v8, -v96, v120, v8
  v_fmac_f32 v9, v96, v112
  v_cvt_pk_bf16_f32 v104, v8, -v9
  v_mul_f32 v10, v89, v113
  v_mul_f32 v11, v89, v121
  v_fma_f32 v10, -v97, v121, v10
  v_fmac_f32 v11, v97, v113
  v_cvt_pk_bf16_f32 v105, v10, -v11
  v_mul_f32 v12, v90, v114
  v_mul_f32 v13, v90, v122
  v_fma_f32 v12, -v98, v122, v12
  v_fmac_f32 v13, v98, v114
  v_cvt_pk_bf16_f32 v106, v12, -v13
  v_mul_f32 v14, v91, v115
  v_mul_f32 v15, v91, v123
  v_fma_f32 v14, -v99, v123, v14
  v_fmac_f32 v15, v99, v115
  v_cvt_pk_bf16_f32 v107, v14, -v15
  v_mul_f32 v8, v92, v116
  v_mul_f32 v9, v92, v124
  v_fma_f32 v8, -v100, v124, v8
  v_fmac_f32 v9, v100, v116
  v_cvt_pk_bf16_f32 v108, v8, -v9
  v_mul_f32 v10, v93, v117
  v_mul_f32 v11, v93, v125
  v_fma_f32 v10, -v101, v125, v10
  v_fmac_f32 v11, v101, v117
  v_cvt_pk_bf16_f32 v109, v10, -v11
  v_mul_f32 v12, v94, v118
  v_mul_f32 v13, v94, v126
  v_fma_f32 v12, -v102, v126, v12
  v_fmac_f32 v13, v102, v118
  v_cvt_pk_bf16_f32 v110, v12, -v13
  v_mul_f32 v14, v95, v119
  v_mul_f32 v15, v95, v127
  v_fma_f32 v14, -v103, v127, v14
  v_fmac_f32 v15, v103, v119
  v_cvt_pk_bf16_f32 v111, v14, -v15
  v_mfma_f32_16x16x32_bf16 v[72:75], v[104:107], v[160:163], 0
  v_mfma_f32_16x16x32_bf16 v[80:83], v[104:107], v[176:179], 0
  v_mfma_f32_16x16x32_bf16 v[76:79], v[104:107], v[168:171], 0
  v_mfma_f32_16x16x32_bf16 v[84:87], v[104:107], v[184:187], 0
  v_mfma_f32_16x16x32_bf16 v[72:75], v[108:111], v[164:167], v[72:75]
  v_mfma_f32_16x16x32_bf16 v[80:83], v[108:111], v[180:183], v[80:83]
  v_mfma_f32_16x16x32_bf16 v[76:79], v[108:111], v[172:175], v[76:79]
  v_mfma_f32_16x16x32_bf16 v[84:87], v[108:111], v[188:191], v[84:87]
  s_lshl_b32 s68, s64, 11
  s_add_u32 s65, s68, 147456
  v_add_u32 v16, s65, v3
  v_add_u32 v7, 147456, v3
  v_mov_b32 v4, 155648
  v_mov_b32 v5, 1
  v_mul_f32 v8, v72, v208
  v_mul_f32 v9, v80, v208
  v_fmac_f32 v8, v80, v209
  v_fma_f32 v9, -v72, v209, v9
  v_cvt_pk_bf16_f32 v104, v8, v9
  v_mul_f32 v10, v73, v210
  v_mul_f32 v11, v81, v210
  v_fmac_f32 v10, v81, v211
  v_fma_f32 v11, -v73, v211, v11
  v_cvt_pk_bf16_f32 v105, v10, v11
  v_mul_f32 v12, v74, v212
  v_mul_f32 v13, v82, v212
  v_fmac_f32 v12, v82, v213
  v_fma_f32 v13, -v74, v213, v13
  v_cvt_pk_bf16_f32 v106, v12, v13
  v_mul_f32 v14, v75, v214
  v_mul_f32 v15, v83, v214
  v_fmac_f32 v14, v83, v215
  v_fma_f32 v15, -v75, v215, v15
  v_cvt_pk_bf16_f32 v107, v14, v15
  v_mul_f32 v8, v76, v216
  v_mul_f32 v9, v84, v216
  v_fmac_f32 v8, v84, v217
  v_fma_f32 v9, -v76, v217, v9
  v_cvt_pk_bf16_f32 v108, v8, v9
  v_mul_f32 v10, v77, v218
  v_mul_f32 v11, v85, v218
  v_fmac_f32 v10, v85, v219
  v_fma_f32 v11, -v77, v219, v11
  v_cvt_pk_bf16_f32 v109, v10, v11
  v_mul_f32 v12, v78, v220
  v_mul_f32 v13, v86, v220
  v_fmac_f32 v12, v86, v221
  v_fma_f32 v13, -v78, v221, v13
  v_cvt_pk_bf16_f32 v110, v12, v13
  v_mul_f32 v14, v79, v222
  v_mul_f32 v15, v87, v222
  v_fmac_f32 v14, v87, v223
  v_fma_f32 v15, -v79, v223, v15
  v_cvt_pk_bf16_f32 v111, v14, v15
  ds_write_b128 v16, v[104:107]
  ds_write_b128 v16, v[108:111] offset:1024
  s_waitcnt lgkmcnt(0)
  s_mov_b64 exec, 1
  ds_add_u32 v4, v5
  s_mov_b64 exec, -1
  s_mul_i32 s69, s63, 8448
  s_add_u32 s68, s68, s69
  s_mov_b32 s77, 400000
fft_sp:
  ds_read_b32 v5, v4
  s_waitcnt lgkmcnt(0)
  v_readfirstlane_b32 s65, v5
  s_sub_u32 s77, s77, 1
  s_cbranch_scc1 fft_spok
  s_cmp_lt_u32 s65, 4
  s_cbranch_scc1 fft_sp
fft_spok:
  ds_read_b128 v[32:35], v7 offset:0
  ds_read_b128 v[48:51], v7 offset:1024
  ds_read_b128 v[36:39], v7 offset:2048
  ds_read_b128 v[52:55], v7 offset:3072
  ds_read_b128 v[40:43], v7 offset:4096
  ds_read_b128 v[56:59], v7 offset:5120
  ds_read_b128 v[44:47], v7 offset:6144
  ds_read_b128 v[60:63], v7 offset:7168
  s_waitcnt lgkmcnt(6)
  v_mfma_f32_16x16x32_bf16 v[88:91], v[128:131], v[32:35], 0
  v_mfma_f32_16x16x32_bf16 v[96:99], v[144:147], v[32:35], 0
  v_mfma_f32_16x16x32_bf16 v[92:95], v[128:131], v[48:51], 0
  v_mfma_f32_16x16x32_bf16 v[100:103], v[144:147], v[48:51], 0
  s_waitcnt lgkmcnt(4)
  v_mfma_f32_16x16x32_bf16 v[88:91], v[132:135], v[36:39], v[88:91]
  v_mfma_f32_16x16x32_bf16 v[96:99], v[148:151], v[36:39], v[96:99]
  v_mfma_f32_16x16x32_bf16 v[92:95], v[132:135], v[52:55], v[92:95]
  v_mfma_f32_16x16x32_bf16 v[100:103], v[148:151], v[52:55], v[100:103]
  s_waitcnt lgkmcnt(2)
  v_mfma_f32_16x16x32_bf16 v[88:91], v[136:139], v[40:43], v[88:91]
  v_mfma_f32_16x16x32_bf16 v[96:99], v[152:155], v[40:43], v[96:99]
  v_mfma_f32_16x16x32_bf16 v[92:95], v[136:139], v[56:59], v[92:95]
  v_mfma_f32_16x16x32_bf16 v[100:103], v[152:155], v[56:59], v[100:103]
  s_waitcnt lgkmcnt(0)
  v_mfma_f32_16x16x32_bf16 v[88:91], v[140:143], v[44:47], v[88:91]
  v_mfma_f32_16x16x32_bf16 v[96:99], v[156:159], v[44:47], v[96:99]
  v_mfma_f32_16x16x32_bf16 v[92:95], v[140:143], v[60:63], v[92:95]
  v_mfma_f32_16x16x32_bf16 v[100:103], v[156:159], v[60:63], v[100:103]
  s_nop 5
  v_cvt_pk_bf16_f32 v104, v88, v96
  v_cvt_pk_bf16_f32 v105, v89, v97
  v_cvt_pk_bf16_f32 v106, v90, v98
  v_cvt_pk_bf16_f32 v107, v91, v99
  v_cvt_pk_bf16_f32 v108, v92, v100
  v_cvt_pk_bf16_f32 v109, v93, v101
  v_cvt_pk_bf16_f32 v110, v94, v102
  v_cvt_pk_bf16_f32 v111, v95, v103
  buffer_store_dwordx4 v[104:107], v6, s[44:47], s68 offen offset:0 sc0 sc1
  buffer_store_dwordx4 v[108:111], v6, s[44:47], s68 offen offset:256 sc0 sc1
  s_cmp_lg_u32 s76, 0
  s_cbranch_scc1 fft_end
  s_branch gemm2h
hk12:
  s_mov_b32 s77, 400000
hk12_sp:
  ds_read_b32 v31, v30 offset:48
  s_waitcnt lgkmcnt(0)
  v_readfirstlane_b32 s73, v31
  s_sub_u32 s77, s77, 1
  s_cbranch_scc1 hk12_go
  s_cmp_lt_u32 s73, 4
  s_cbranch_scc1 hk12_sp
hk12_go:
  s_add_u32 s85, s61, 0
  s_cmp_ge_u32 s85, 7
  s_cselect_b32 s73, 7, 0
  s_sub_u32 s85, s85, s73
  s_mul_i32 s85, s85, 28672
  s_add_u32 s85, s85, s75
  s_add_u32 s73, s85, 0
  s_add_u32 m0, s87, 98304
  s_nop 0
  buffer_load_dwordx4 v29, s[36:39], s73 offen lds
  s_add_u32 s73, s85, 7168
  s_add_u32 m0, s87, 99328
  s_nop 0
  buffer_load_dwordx4 v29, s[36:39], s73 offen lds
  s_add_u32 s73, s85, 14336
  s_add_u32 m0, s87, 100352
  s_nop 0
  buffer_load_dwordx4 v29, s[36:39], s73 offen lds
  s_add_u32 s73, s85, 21504
  s_add_u32 m0, s87, 101376
  s_nop 0
  buffer_load_dwordx4 v29, s[36:39], s73 offen lds
  s_add_u32 s85, s61, 1
  s_cmp_ge_u32 s85, 7
  s_cselect_b32 s73, 7, 0
  s_sub_u32 s85, s85, s73
  s_mul_i32 s85, s85, 28672
  s_add_u32 s85, s85, s75
  s_add_u32 s73, s85, 0
  s_add_u32 m0, s87, 114688
  s_nop 0
  buffer_load_dwordx4 v29, s[36:39], s73 offen lds
  s_add_u32 s73, s85, 7168
  s_add_u32 m0, s87, 115712
  s_nop 0
  buffer_load_dwordx4 v29, s[36:39], s73 offen lds
  s_add_u32 s73, s85, 14336
  s_add_u32 m0, s87, 116736
  s_nop 0
  buffer_load_dwordx4 v29, s[36:39], s73 offen lds
  s_add_u32 s73, s85, 21504
  s_add_u32 m0, s87, 117760
  s_nop 0
  buffer_load_dwordx4 v29, s[36:39], s73 offen lds
  s_branch hk12_ret
fd_slow:
  s_waitcnt vmcnt(0)
  ds_write_b32 v8, v9
  s_cmp_lg_u32 s64, 0
  s_cbranch_scc1 fd_w
  s_mov_b32 s77, 20000
  s_branch fd_ld
fd_pl:
  v_cmp_ne_u32 vcc, 32, v17
  s_nop 1
  s_cbranch_vccz fd_ok
  s_sub_u32 s77, s77, 1
  s_cbranch_scc1 fd_ok
  s_sub_u32 s79, s79, 0
  s_sleep 4
fd_ld:
  buffer_load_dword v17, v18, s[40:43], 0 offen sc1
  s_waitcnt vmcnt(0)
  s_branch fd_pl
fd_ok:
  v_mov_b32 v18, 155776
  ds_write_b32 v18, v9 offset:4
  s_branch fd_go
fd_w:
  v_mov_b32 v18, 155780
  s_mov_b32 s77, 400000
  s_branch fd_sp_1
fd_sp:
  s_sleep 1
fd_sp_1:
  ds_read_b32 v17, v18 offset:0
  s_waitcnt lgkmcnt(0)
  v_readfirstlane_b32 s73, v17
  s_sub_u32 s77, s77, 1
  s_cbranch_scc1 fd_sp_ok
  s_cmp_lt_u32 s73, 1
  s_cbranch_scc1 fd_sp
fd_sp_ok:
  s_branch fd_go
fft_end:
  v_mov_b32 v30, 1
  s_waitcnt vmcnt(0)
  buffer_store_dword v30, v28, s[40:43], 0 offen sc0 sc1
  s_endpgm
gemm2:
  s_lshl_b32 s87, s64, 12
  s_lshl_b32 s86, s64, 2
  s_add_u32 s86, s86, 155712
  v_lshrrev_b32 v5, 5, v0
  v_and_b32 v4, 31, v0
  v_lshlrev_b32 v3, 4, v0
  v_bfe_u32 v1, v0, 2, 2
  v_lshl_add_u32 v2, v5, 2, v1
  v_lshlrev_b32 v2, 7, v2
  v_lshrrev_b32 v1, 1, v1
  v_lshl_add_u32 v2, v1, 6, v2
  v_bfe_u32 v1, v0, 4, 1
  v_lshl_add_u32 v2, v1, 5, v2
  v_and_b32 v1, 3, v0
  v_lshl_add_u32 v2, v1, 3, v2
  v_add_u32 v2, s87, v2
  v_add_u32 v1, 81920, v2
  v_xor_b32 v5, 64, v1
  ds_read_b64_tr_b16 v[128:129], v1 offset:0
  ds_read_b64_tr_b16 v[130:131], v1 offset:1024
  ds_read_b64_tr_b16 v[132:133], v5 offset:0
  ds_read_b64_tr_b16 v[134:135], v5 offset:1024
  ds_read_b64_tr_b16 v[136:137], v1 offset:2048
  ds_read_b64_tr_b16 v[138:139], v1 offset:3072
  ds_read_b64_tr_b16 v[140:141], v5 offset:2048
  ds_read_b64_tr_b16 v[142:143], v5 offset:3072
  v_add_u32 v1, 49152, v2
  v_xor_b32 v5, 64, v1
  ds_read_b64_tr_b16 v[144:145], v1 offset:0
  ds_read_b64_tr_b16 v[146:147], v1 offset:1024
  ds_read_b64_tr_b16 v[148:149], v5 offset:0
  ds_read_b64_tr_b16 v[150:151], v5 offset:1024
  ds_read_b64_tr_b16 v[152:153], v1 offset:2048
  ds_read_b64_tr_b16 v[154:155], v1 offset:3072
  ds_read_b64_tr_b16 v[156:157], v5 offset:2048
  ds_read_b64_tr_b16 v[158:159], v5 offset:3072
  v_add_u32 v1, 65536, v2
  v_xor_b32 v5, 64, v1
  ds_read_b64_tr_b16 v[160:161], v1 offset:0
  ds_read_b64_tr_b16 v[162:163], v1 offset:1024
  ds_read_b64_tr_b16 v[164:165], v5 offset:0
  ds_read_b64_tr_b16 v[166:167], v5 offset:1024
  ds_read_b64_tr_b16 v[168:169], v1 offset:2048
  ds_read_b64_tr_b16 v[170:171], v1 offset:3072
  ds_read_b64_tr_b16 v[172:173], v5 offset:2048
  ds_read_b64_tr_b16 v[174:175], v5 offset:3072
  v_add_u32 v1, 131072, v2
  v_xor_b32 v5, 64, v1
  ds_read_b64_tr_b16 v[176:177], v1 offset:0
  ds_read_b64_tr_b16 v[178:179], v1 offset:1024
  ds_read_b64_tr_b16 v[180:181], v5 offset:0
  ds_read_b64_tr_b16 v[182:183], v5 offset:1024
  ds_read_b64_tr_b16 v[184:185], v1 offset:2048
  ds_read_b64_tr_b16 v[186:187], v1 offset:3072
  ds_read_b64_tr_b16 v[188:189], v5 offset:2048
  ds_read_b64_tr_b16 v[190:191], v5 offset:3072
  s_mul_i32 s65, s3, 14
  s_mul_i32 s73, s60, 226
  s_add_u32 s73, s73, s65
  s_lshl_b32 s73, s73, 10
  s_add_u32 s65, s73, 115712
  s_add_u32 s28, s22, s73
  s_addc_u32 s29, s23, 0
  s_mov_b32 s30, 71680
  s_mov_b32 s31, 0x00020000
  s_add_u32 s32, s22, s65
  s_addc_u32 s33, s23, 0
  s_mov_b32 s34, 71680
  s_mov_b32 s35, 0x00020000
  s_add_u32 s52, s22, 13165312
  s_addc_u32 s53, s23, 0
  s_mov_b32 s54, 16384
  s_mov_b32 s55, 0x00020000
  s_add_u32 s40, s22, 13181696
  s_addc_u32 s41, s23, 0
  s_mov_b32 s42, 65536
  s_mov_b32 s43, 0x00020000
  s_mul_i32 s74, s3, 200704
  s_lshl_b32 s75, s61, 7
  s_add_u32 s74, s74, s75
  v_lshlrev_b32 v10, 2, v4
  s_lshl_b32 s85, s60, 8
  s_add_u32 s85, s85, 8192
  v_mov_b32 v8, v29
  v_add_u32 v9, 57344, v3
  v_mov_b32 v30, 1
  s_add_u32 s66, s61, 0
  s_cmp_ge_u32 s66, 7
  s_cselect_b32 s75, 7, 0
  s_sub_u32 s66, s66, s75
  s_lshl_b32 s66, s66, 11
  s_add_u32 s67, s61, 1
  s_cmp_ge_u32 s67, 7
  s_cselect_b32 s75, 7, 0
  s_sub_u32 s67, s67, s75
  s_lshl_b32 s67, s67, 11
  s_add_u32 s68, s61, 2
  s_cmp_ge_u32 s68, 7
  s_cselect_b32 s75, 7, 0
  s_sub_u32 s68, s68, s75
  s_lshl_b32 s68, s68, 11
  s_add_u32 s69, s61, 3
  s_cmp_ge_u32 s69, 7
  s_cselect_b32 s75, 7, 0
  s_sub_u32 s69, s69, s75
  s_lshl_b32 s69, s69, 11
  s_add_u32 s70, s61, 4
  s_cmp_ge_u32 s70, 7
  s_cselect_b32 s75, 7, 0
  s_sub_u32 s70, s70, s75
  s_lshl_b32 s70, s70, 11
  s_add_u32 s71, s61, 5
  s_cmp_ge_u32 s71, 7
  s_cselect_b32 s75, 7, 0
  s_sub_u32 s71, s71, s75
  s_lshl_b32 s71, s71, 11
  s_add_u32 s72, s61, 6
  s_cmp_ge_u32 s72, 7
  s_cselect_b32 s75, 7, 0
  s_sub_u32 s72, s72, s75
  s_lshl_b32 s72, s72, 11
  s_waitcnt lgkmcnt(0)
  s_mul_i32 s73, s70, 14
  s_add_u32 s73, s73, s74
  s_add_u32 s75, s73, 0
  s_add_u32 m0, s87, 81920
  s_nop 0
  buffer_load_dwordx4 v8, s[36:39], s75 offen lds
  s_add_u32 s75, s73, 7168
  s_add_u32 m0, s87, 82944
  s_nop 0
  buffer_load_dwordx4 v8, s[36:39], s75 offen lds
  s_add_u32 s75, s73, 14336
  s_add_u32 m0, s87, 83968
  s_nop 0
  buffer_load_dwordx4 v8, s[36:39], s75 offen lds
  s_add_u32 s75, s73, 21504
  s_add_u32 m0, s87, 84992
  s_nop 0
  buffer_load_dwordx4 v8, s[36:39], s75 offen lds
  s_mul_i32 s73, s71, 14
  s_add_u32 s73, s73, s74
  s_add_u32 s75, s73, 0
  s_add_u32 m0, s87, 49152
  s_nop 0
  buffer_load_dwordx4 v8, s[36:39], s75 offen lds
  s_add_u32 s75, s73, 7168
  s_add_u32 m0, s87, 50176
  s_nop 0
  buffer_load_dwordx4 v8, s[36:39], s75 offen lds
  s_add_u32 s75, s73, 14336
  s_add_u32 m0, s87, 51200
  s_nop 0
  buffer_load_dwordx4 v8, s[36:39], s75 offen lds
  s_add_u32 s75, s73, 21504
  s_add_u32 m0, s87, 52224
  s_nop 0
  buffer_load_dwordx4 v8, s[36:39], s75 offen lds
  s_waitcnt vmcnt(8)
  buffer_store_dword v30, v28, s[40:43], 0 offen sc0 sc1
  v_mov_b32 v14, 155776
  s_mov_b32 s77, 400000
g2_rc:
  ds_read_b32 v15, v14 offset:56
  s_waitcnt lgkmcnt(0)
  v_readfirstlane_b32 s73, v15
  s_sub_u32 s77, s77, 1
  s_cbranch_scc1 g2_rc_ok
  s_cmp_lt_u32 s73, 4
  s_cbranch_scc1 g2_rc
g2_rc_ok:
  buffer_load_dword v6, v10, s[52:55], s85 offen offset:0 sc1
  buffer_load_dword v7, v10, s[52:55], s85 offen offset:128 sc1
  s_lshr_b32 s65, s60, 1
  s_lshl_b32 s65, s65, 3
  s_add_u32 s65, s65, s3
  s_lshl_b32 s65, s65, 7
  s_add_u32 s65, s65, 8192
  v_and_b32 v1, 7, v0
  v_min_u32 v1, 6, v1
  v_lshlrev_b32 v1, 2, v1
  v_bfe_u32 v11, v0, 3, 1
  v_lshl_add_u32 v1, v11, 9, v1
  v_add_u32 v1, s65, v1
  v_mov_b32 v11, 1
  s_mul_i32 s73, s72, 14
  s_add_u32 s73, s73, s74
  s_add_u32 s75, s73, 0
  s_add_u32 m0, s87, 65536
  s_nop 0
  buffer_load_dwordx4 v8, s[36:39], s75 offen lds
  s_add_u32 s75, s73, 7168
  s_add_u32 m0, s87, 66560
  s_nop 0
  buffer_load_dwordx4 v8, s[36:39], s75 offen lds
  s_add_u32 s75, s73, 14336
  s_add_u32 m0, s87, 67584
  s_nop 0
  buffer_load_dwordx4 v8, s[36:39], s75 offen lds
  s_add_u32 s75, s73, 21504
  s_add_u32 m0, s87, 68608
  s_nop 0
  buffer_load_dwordx4 v8, s[36:39], s75 offen lds
  s_mul_i32 s73, s68, 14
  s_add_u32 s73, s73, s74
  s_add_u32 s75, s73, 802816
  s_add_u32 m0, s87, 0
  s_nop 0
  buffer_load_dwordx4 v8, s[36:39], s75 offen lds
  s_add_u32 s75, s73, 809984
  s_add_u32 m0, s87, 1024
  s_nop 0
  buffer_load_dwordx4 v8, s[36:39], s75 offen lds
  s_add_u32 s75, s73, 817152
  s_add_u32 m0, s87, 2048
  s_nop 0
  buffer_load_dwordx4 v8, s[36:39], s75 offen lds
  s_add_u32 s75, s73, 824320
  s_add_u32 m0, s87, 3072
  s_nop 0
  buffer_load_dwordx4 v8, s[36:39], s75 offen lds
  s_mul_i32 s73, s69, 14
  s_add_u32 s73, s73, s74
  s_add_u32 s75, s73, 802816
  s_add_u32 m0, s87, 16384
  s_nop 0
  buffer_load_dwordx4 v8, s[36:39], s75 offen lds
  s_add_u32 s75, s73, 809984
  s_add_u32 m0, s87, 17408
  s_nop 0
  buffer_load_dwordx4 v8, s[36:39], s75 offen lds
  s_add_u32 s75, s73, 817152
  s_add_u32 m0, s87, 18432
  s_nop 0
  buffer_load_dwordx4 v8, s[36:39], s75 offen lds
  s_add_u32 s75, s73, 824320
  s_add_u32 m0, s87, 19456
  s_nop 0
  buffer_load_dwordx4 v8, s[36:39], s75 offen lds
  s_mul_i32 s73, s70, 14
  s_add_u32 s73, s73, s74
  s_add_u32 s75, s73, 802816
  s_add_u32 m0, s87, 131072
  s_nop 0
  buffer_load_dwordx4 v8, s[36:39], s75 offen lds
  s_add_u32 s75, s73, 809984
  s_add_u32 m0, s87, 132096
  s_nop 0
  buffer_load_dwordx4 v8, s[36:39], s75 offen lds
  s_add_u32 s75, s73, 817152
  s_add_u32 m0, s87, 133120
  s_nop 0
  buffer_load_dwordx4 v8, s[36:39], s75 offen lds
  s_add_u32 s75, s73, 824320
  s_add_u32 m0, s87, 134144
  s_nop 0
  buffer_load_dwordx4 v8, s[36:39], s75 offen lds
  s_mul_i32 s73, s71, 14
  s_add_u32 s73, s73, s74
  s_add_u32 s75, s73, 802816
  s_add_u32 m0, s87, 32768
  s_nop 0
  buffer_load_dwordx4 v8, s[36:39], s75 offen lds
  s_add_u32 s75, s73, 809984
  s_add_u32 m0, s87, 33792
  s_nop 0
  buffer_load_dwordx4 v8, s[36:39], s75 offen lds
  s_add_u32 s75, s73, 817152
  s_add_u32 m0, s87, 34816
  s_nop 0
  buffer_load_dwordx4 v8, s[36:39], s75 offen lds
  s_add_u32 s75, s73, 824320
  s_add_u32 m0, s87, 35840
  s_nop 0
  buffer_load_dwordx4 v8, s[36:39], s75 offen lds
  buffer_load_dword v192, v1, s[40:43], 0 offen sc1
  s_waitcnt vmcnt(0)
  s_mov_b32 s77, 20000
fh_pl:
  v_cmp_ne_u32 vcc, 1, v192
  s_nop 1
  s_cbranch_vccz fh_ok
  s_sub_u32 s77, s77, 1
  s_cbranch_scc1 fh_ok
  s_sub_u32 s79, s79, 0
  s_sleep 2
fh_ld:
  buffer_load_dword v192, v1, s[40:43], 0 offen sc1
  s_waitcnt vmcnt(0)
  s_branch fh_pl
fh_ok:
  v_mov_b32 v14, s86
  s_mov_b32 s77, 400000
  s_branch g2_b_1
g2_b:
  s_sleep 1
g2_b_1:
  ds_read_b32 v15, v14 offset:32
  s_waitcnt lgkmcnt(0)
  v_readfirstlane_b32 s73, v15
  s_sub_u32 s77, s77, 1
  s_cbranch_scc1 g2_b_ok
  s_cmp_lt_u32 s73, 1
  s_cbranch_scc1 g2_b
g2_b_ok:
  buffer_load_dwordx4 v[16:19], v3, s[28:31], s66 offen offset:0
  buffer_load_dwordx4 v[20:23], v3, s[32:35], s66 offen offset:0
  buffer_load_dwordx4 v[24:27], v3, s[28:31], s66 offen offset:1024
  buffer_load_dwordx4 v[28:31], v3, s[32:35], s66 offen offset:1024
  buffer_load_dwordx4 v[32:35], v3, s[28:31], s67 offen offset:0
  buffer_load_dwordx4 v[36:39], v3, s[32:35], s67 offen offset:0
  buffer_load_dwordx4 v[40:43], v3, s[28:31], s67 offen offset:1024
  buffer_load_dwordx4 v[44:47], v3, s[32:35], s67 offen offset:1024
  buffer_load_dwordx4 v[48:51], v3, s[28:31], s68 offen offset:0
  buffer_load_dwordx4 v[52:55], v3, s[32:35], s68 offen offset:0
  buffer_load_dwordx4 v[56:59], v3, s[28:31], s68 offen offset:1024
  buffer_load_dwordx4 v[60:63], v3, s[32:35], s68 offen offset:1024
  buffer_load_dwordx4 v[64:67], v3, s[28:31], s69 offen offset:0
  buffer_load_dwordx4 v[68:71], v3, s[32:35], s69 offen offset:0
  buffer_load_dwordx4 v[72:75], v3, s[28:31], s69 offen offset:1024
  buffer_load_dwordx4 v[76:79], v3, s[32:35], s69 offen offset:1024
  buffer_load_dwordx4 v[80:83], v3, s[28:31], s70 offen offset:0
  buffer_load_dwordx4 v[84:87], v3, s[32:35], s70 offen offset:0
  buffer_load_dwordx4 v[88:91], v3, s[28:31], s70 offen offset:1024
  buffer_load_dwordx4 v[92:95], v3, s[32:35], s70 offen offset:1024
  buffer_load_dwordx4 v[96:99], v3, s[28:31], s71 offen offset:0
  buffer_load_dwordx4 v[100:103], v3, s[32:35], s71 offen offset:0
  buffer_load_dwordx4 v[104:107], v3, s[28:31], s71 offen offset:1024
  buffer_load_dwordx4 v[108:111], v3, s[32:35], s71 offen offset:1024
  buffer_load_dwordx4 v[112:115], v3, s[28:31], s72 offen offset:0
  buffer_load_dwordx4 v[116:119], v3, s[32:35], s72 offen offset:0
  buffer_load_dwordx4 v[120:123], v3, s[28:31], s72 offen offset:1024
  buffer_load_dwordx4 v[124:127], v3, s[32:35], s72 offen offset:1024
  s_mov_b32 s48, s18
  s_mov_b32 s49, s19
  s_mov_b32 s50, 1835008
  s_mov_b32 s51, 0x00020000
  s_lshr_b32 s65, s3, 1
  s_and_b32 s76, s65, 1
  s_lshl_b32 s76, s76, 2
  s_lshr_b32 s78, s60, 1
  s_lshl_b32 s78, s78, 3
  s_add_u32 s76, s76, s78
  s_and_b32 s78, s60, 1
  s_add_u32 s76, s76, s78
  s_mul_i32 s76, s76, 14336
  s_lshr_b32 s65, s65, 1
  s_lshl_b32 s78, s61, 1
  s_add_u32 s78, s78, s65
  s_lshl_b32 s78, s78, 6
  s_add_u32 s76, s76, s78
  s_and_b32 s78, s3, 1
  s_lshl_b32 s78, s78, 5
  s_add_u32 s76, s76, s78
  v_and_b32 v12, 15, v0
  v_bfe_u32 v13, v0, 4, 1
  v_lshl_add_u32 v12, v13, 5, v12
  v_mul_u32_u24 v12, 896, v12
  v_lshrrev_b32 v14, 5, v0
  v_lshl_add_u32 v13, v14, 3, v12
  v_lshl_add_u32 v12, v14, 4, v12
  s_waitcnt vmcnt(26)
  v_mfma_f32_32x32x16_bf16 v[192:207], v[128:131], v[16:19], 0
  v_mfma_f32_32x32x16_bf16 v[224:239], v[132:135], v[16:19], 0
  v_mfma_f32_32x32x16_bf16 v[208:223], v[128:131], v[20:23], 0
  v_mfma_f32_32x32x16_bf16 v[240:255], v[132:135], v[20:23], 0
  buffer_load_dwordx4 v[16:19], v9, s[28:31], s66 offen offset:0
  buffer_load_dwordx4 v[20:23], v9, s[32:35], s66 offen offset:0
  s_waitcnt vmcnt(26)
  v_mfma_f32_32x32x16_bf16 v[192:207], v[136:139], v[24:27], v[192:207]
  v_mfma_f32_32x32x16_bf16 v[224:239], v[140:143], v[24:27], v[224:239]
  v_mfma_f32_32x32x16_bf16 v[208:223], v[136:139], v[28:31], v[208:223]
  v_mfma_f32_32x32x16_bf16 v[240:255], v[140:143], v[28:31], v[240:255]
  buffer_load_dwordx4 v[24:27], v9, s[28:31], s66 offen offset:1024
  buffer_load_dwordx4 v[28:31], v9, s[32:35], s66 offen offset:1024
  s_waitcnt vmcnt(26)
  v_mfma_f32_32x32x16_bf16 v[192:207], v[144:147], v[32:35], v[192:207]
  v_mfma_f32_32x32x16_bf16 v[224:239], v[148:151], v[32:35], v[224:239]
  v_mfma_f32_32x32x16_bf16 v[208:223], v[144:147], v[36:39], v[208:223]
  v_mfma_f32_32x32x16_bf16 v[240:255], v[148:151], v[36:39], v[240:255]
  buffer_load_dwordx4 v[32:35], v9, s[28:31], s67 offen offset:0
  buffer_load_dwordx4 v[36:39], v9, s[32:35], s67 offen offset:0
  s_waitcnt vmcnt(26)
  v_mfma_f32_32x32x16_bf16 v[192:207], v[152:155], v[40:43], v[192:207]
  v_mfma_f32_32x32x16_bf16 v[224:239], v[156:159], v[40:43], v[224:239]
  v_mfma_f32_32x32x16_bf16 v[208:223], v[152:155], v[44:47], v[208:223]
  v_mfma_f32_32x32x16_bf16 v[240:255], v[156:159], v[44:47], v[240:255]
  buffer_load_dwordx4 v[40:43], v9, s[28:31], s67 offen offset:1024
  buffer_load_dwordx4 v[44:47], v9, s[32:35], s67 offen offset:1024
  s_waitcnt vmcnt(26)
  v_mfma_f32_32x32x16_bf16 v[192:207], v[160:163], v[48:51], v[192:207]
  v_mfma_f32_32x32x16_bf16 v[224:239], v[164:167], v[48:51], v[224:239]
  v_mfma_f32_32x32x16_bf16 v[208:223], v[160:163], v[52:55], v[208:223]
  v_mfma_f32_32x32x16_bf16 v[240:255], v[164:167], v[52:55], v[240:255]
  buffer_load_dwordx4 v[48:51], v9, s[28:31], s68 offen offset:0
  buffer_load_dwordx4 v[52:55], v9, s[32:35], s68 offen offset:0
  v_add_u32 v1, 81920, v2
  v_xor_b32 v5, 64, v1
  ds_read_b64_tr_b16 v[128:129], v1 offset:0
  ds_read_b64_tr_b16 v[130:131], v1 offset:1024
  ds_read_b64_tr_b16 v[132:133], v5 offset:0
  ds_read_b64_tr_b16 v[134:135], v5 offset:1024
  s_waitcnt vmcnt(26)
  v_mfma_f32_32x32x16_bf16 v[192:207], v[168:171], v[56:59], v[192:207]
  v_mfma_f32_32x32x16_bf16 v[224:239], v[172:175], v[56:59], v[224:239]
  v_mfma_f32_32x32x16_bf16 v[208:223], v[168:171], v[60:63], v[208:223]
  v_mfma_f32_32x32x16_bf16 v[240:255], v[172:175], v[60:63], v[240:255]
  buffer_load_dwordx4 v[56:59], v9, s[28:31], s68 offen offset:1024
  buffer_load_dwordx4 v[60:63], v9, s[32:35], s68 offen offset:1024
  ds_read_b64_tr_b16 v[136:137], v1 offset:2048
  ds_read_b64_tr_b16 v[138:139], v1 offset:3072
  ds_read_b64_tr_b16 v[140:141], v5 offset:2048
  ds_read_b64_tr_b16 v[142:143], v5 offset:3072
  s_waitcnt vmcnt(26)
  v_mfma_f32_32x32x16_bf16 v[192:207], v[176:179], v[64:67], v[192:207]
  v_mfma_f32_32x32x16_bf16 v[224:239], v[180:183], v[64:67], v[224:239]
  v_mfma_f32_32x32x16_bf16 v[208:223], v[176:179], v[68:71], v[208:223]
  v_mfma_f32_32x32x16_bf16 v[240:255], v[180:183], v[68:71], v[240:255]
  buffer_load_dwordx4 v[64:67], v9, s[28:31], s69 offen offset:0
  buffer_load_dwordx4 v[68:71], v9, s[32:35], s69 offen offset:0
  v_add_u32 v1, 49152, v2
  v_xor_b32 v5, 64, v1
  ds_read_b64_tr_b16 v[144:145], v1 offset:0
  ds_read_b64_tr_b16 v[146:147], v1 offset:1024
  ds_read_b64_tr_b16 v[148:149], v5 offset:0
  ds_read_b64_tr_b16 v[150:151], v5 offset:1024
  s_waitcnt vmcnt(26)
  v_mfma_f32_32x32x16_bf16 v[192:207], v[184:187], v[72:75], v[192:207]
  v_mfma_f32_32x32x16_bf16 v[224:239], v[188:191], v[72:75], v[224:239]
  v_mfma_f32_32x32x16_bf16 v[208:223], v[184:187], v[76:79], v[208:223]
  v_mfma_f32_32x32x16_bf16 v[240:255], v[188:191], v[76:79], v[240:255]
  buffer_load_dwordx4 v[72:75], v9, s[28:31], s69 offen offset:1024
  buffer_load_dwordx4 v[76:79], v9, s[32:35], s69 offen offset:1024
  ds_read_b64_tr_b16 v[152:153], v1 offset:2048
  ds_read_b64_tr_b16 v[154:155], v1 offset:3072
  ds_read_b64_tr_b16 v[156:157], v5 offset:2048
  ds_read_b64_tr_b16 v[158:159], v5 offset:3072
  s_waitcnt vmcnt(26)
  s_waitcnt lgkmcnt(12)
  v_mfma_f32_32x32x16_bf16 v[192:207], v[128:131], v[80:83], v[192:207]
  v_mfma_f32_32x32x16_bf16 v[224:239], v[132:135], v[80:83], v[224:239]
  v_mfma_f32_32x32x16_bf16 v[208:223], v[128:131], v[84:87], v[208:223]
  v_mfma_f32_32x32x16_bf16 v[240:255], v[132:135], v[84:87], v[240:255]
  buffer_load_dwordx4 v[80:83], v9, s[28:31], s70 offen offset:0
  buffer_load_dwordx4 v[84:87], v9, s[32:35], s70 offen offset:0
  v_add_u32 v1, 65536, v2
  v_xor_b32 v5, 64, v1
  ds_read_b64_tr_b16 v[160:161], v1 offset:0
  ds_read_b64_tr_b16 v[162:163], v1 offset:1024
  ds_read_b64_tr_b16 v[164:165], v5 offset:0
  ds_read_b64_tr_b16 v[166:167], v5 offset:1024
  s_waitcnt vmcnt(26)
  s_waitcnt lgkmcnt(12)
  v_mfma_f32_32x32x16_bf16 v[192:207], v[136:139], v[88:91], v[192:207]
  v_mfma_f32_32x32x16_bf16 v[224:239], v[140:143], v[88:91], v[224:239]
  v_mfma_f32_32x32x16_bf16 v[208:223], v[136:139], v[92:95], v[208:223]
  v_mfma_f32_32x32x16_bf16 v[240:255], v[140:143], v[92:95], v[240:255]
  buffer_load_dwordx4 v[88:91], v9, s[28:31], s70 offen offset:1024
  buffer_load_dwordx4 v[92:95], v9, s[32:35], s70 offen offset:1024
  s_mul_i32 s73, s72, 14
  s_add_u32 s73, s73, s74
  s_add_u32 s75, s73, 802816
  s_add_u32 m0, s87, 81920
  s_nop 0
  buffer_load_dwordx4 v8, s[36:39], s75 offen lds
  s_add_u32 s75, s73, 809984
  s_add_u32 m0, s87, 82944
  s_nop 0
  buffer_load_dwordx4 v8, s[36:39], s75 offen lds
  s_add_u32 s75, s73, 817152
  s_add_u32 m0, s87, 83968
  s_nop 0
  buffer_load_dwordx4 v8, s[36:39], s75 offen lds
  s_add_u32 s75, s73, 824320
  s_add_u32 m0, s87, 84992
  s_nop 0
  buffer_load_dwordx4 v8, s[36:39], s75 offen lds
  ds_read_b64_tr_b16 v[168:169], v1 offset:2048
  ds_read_b64_tr_b16 v[170:171], v1 offset:3072
  ds_read_b64_tr_b16 v[172:173], v5 offset:2048
  ds_read_b64_tr_b16 v[174:175], v5 offset:3072
  s_waitcnt vmcnt(30)
  s_waitcnt lgkmcnt(12)
  v_mfma_f32_32x32x16_bf16 v[192:207], v[144:147], v[96:99], v[192:207]
  v_mfma_f32_32x32x16_bf16 v[224:239], v[148:151], v[96:99], v[224:239]
  v_mfma_f32_32x32x16_bf16 v[208:223], v[144:147], v[100:103], v[208:223]
  v_mfma_f32_32x32x16_bf16 v[240:255], v[148:151], v[100:103], v[240:255]
  buffer_load_dwordx4 v[96:99], v9, s[28:31], s71 offen offset:0
  buffer_load_dwordx4 v[100:103], v9, s[32:35], s71 offen offset:0
  v_add_u32 v1, 98304, v2
  v_xor_b32 v5, 64, v1
  ds_read_b64_tr_b16 v[176:177], v1 offset:0
  ds_read_b64_tr_b16 v[178:179], v1 offset:1024
  ds_read_b64_tr_b16 v[180:181], v5 offset:0
  ds_read_b64_tr_b16 v[182:183], v5 offset:1024
  s_waitcnt vmcnt(30)
  s_waitcnt lgkmcnt(12)
  v_mfma_f32_32x32x16_bf16 v[192:207], v[152:155], v[104:107], v[192:207]
  v_mfma_f32_32x32x16_bf16 v[224:239], v[156:159], v[104:107], v[224:239]
  v_mfma_f32_32x32x16_bf16 v[208:223], v[152:155], v[108:111], v[208:223]
  v_mfma_f32_32x32x16_bf16 v[240:255], v[156:159], v[108:111], v[240:255]
  buffer_load_dwordx4 v[104:107], v9, s[28:31], s71 offen offset:1024
  buffer_load_dwordx4 v[108:111], v9, s[32:35], s71 offen offset:1024
  ds_read_b64_tr_b16 v[184:185], v1 offset:2048
  ds_read_b64_tr_b16 v[186:187], v1 offset:3072
  ds_read_b64_tr_b16 v[188:189], v5 offset:2048
  ds_read_b64_tr_b16 v[190:191], v5 offset:3072
  s_waitcnt vmcnt(30)
  s_waitcnt lgkmcnt(12)
  v_mfma_f32_32x32x16_bf16 v[192:207], v[160:163], v[112:115], v[192:207]
  v_mfma_f32_32x32x16_bf16 v[224:239], v[164:167], v[112:115], v[224:239]
  v_mfma_f32_32x32x16_bf16 v[208:223], v[160:163], v[116:119], v[208:223]
  v_mfma_f32_32x32x16_bf16 v[240:255], v[164:167], v[116:119], v[240:255]
  buffer_load_dwordx4 v[112:115], v9, s[28:31], s72 offen offset:0
  buffer_load_dwordx4 v[116:119], v9, s[32:35], s72 offen offset:0
  v_add_u32 v1, 114688, v2
  v_xor_b32 v5, 64, v1
  ds_read_b64_tr_b16 v[128:129], v1 offset:0
  ds_read_b64_tr_b16 v[130:131], v1 offset:1024
  ds_read_b64_tr_b16 v[132:133], v5 offset:0
  ds_read_b64_tr_b16 v[134:135], v5 offset:1024
  s_waitcnt vmcnt(30)
  s_waitcnt lgkmcnt(12)
  v_mfma_f32_32x32x16_bf16 v[192:207], v[168:171], v[120:123], v[192:207]
  v_mfma_f32_32x32x16_bf16 v[224:239], v[172:175], v[120:123], v[224:239]
  v_mfma_f32_32x32x16_bf16 v[208:223], v[168:171], v[124:127], v[208:223]
  v_mfma_f32_32x32x16_bf16 v[240:255], v[172:175], v[124:127], v[240:255]
  buffer_load_dwordx4 v[120:123], v9, s[28:31], s72 offen offset:1024
  buffer_load_dwordx4 v[124:127], v9, s[32:35], s72 offen offset:1024
  ds_read_b64_tr_b16 v[136:137], v1 offset:2048
  ds_read_b64_tr_b16 v[138:139], v1 offset:3072
  ds_read_b64_tr_b16 v[140:141], v5 offset:2048
  ds_read_b64_tr_b16 v[142:143], v5 offset:3072
  s_waitcnt vmcnt(30)
  s_waitcnt lgkmcnt(12)
  v_mfma_f32_32x32x16_bf16 v[192:207], v[176:179], v[16:19], v[192:207]
  v_mfma_f32_32x32x16_bf16 v[224:239], v[180:183], v[16:19], v[224:239]
  v_mfma_f32_32x32x16_bf16 v[208:223], v[176:179], v[20:23], v[208:223]
  v_mfma_f32_32x32x16_bf16 v[240:255], v[180:183], v[20:23], v[240:255]
  v_add_u32 v1, 0, v2
  v_xor_b32 v5, 64, v1
  ds_read_b64_tr_b16 v[144:145], v1 offset:0
  ds_read_b64_tr_b16 v[146:147], v1 offset:1024
  ds_read_b64_tr_b16 v[148:149], v5 offset:0
  ds_read_b64_tr_b16 v[150:151], v5 offset:1024
  s_waitcnt vmcnt(28)
  s_waitcnt lgkmcnt(12)
  v_mfma_f32_32x32x16_bf16 v[192:207], v[184:187], v[24:27], v[192:207]
  v_mfma_f32_32x32x16_bf16 v[224:239], v[188:191], v[24:27], v[224:239]
  v_mfma_f32_32x32x16_bf16 v[208:223], v[184:187], v[28:31], v[208:223]
  v_mfma_f32_32x32x16_bf16 v[240:255], v[188:191], v[28:31], v[240:255]
  buffer_load_dwordx2 v[16:17], v13, s[24:27], s76 offen offset:0
  buffer_load_dwordx2 v[18:19], v13, s[24:27], s76 offen offset:16
  ds_read_b64_tr_b16 v[152:153], v1 offset:2048
  ds_read_b64_tr_b16 v[154:155], v1 offset:3072
  ds_read_b64_tr_b16 v[156:157], v5 offset:2048
  ds_read_b64_tr_b16 v[158:159], v5 offset:3072
  s_waitcnt vmcnt(28)
  s_waitcnt lgkmcnt(12)
  v_mfma_f32_32x32x16_bf16 v[192:207], v[128:131], v[32:35], v[192:207]
  v_mfma_f32_32x32x16_bf16 v[224:239], v[132:135], v[32:35], v[224:239]
  v_mfma_f32_32x32x16_bf16 v[208:223], v[128:131], v[36:39], v[208:223]
  v_mfma_f32_32x32x16_bf16 v[240:255], v[132:135], v[36:39], v[240:255]
  v_add_u32 v1, 16384, v2
  v_xor_b32 v5, 64, v1
  ds_read_b64_tr_b16 v[160:161], v1 offset:0
  ds_read_b64_tr_b16 v[162:163], v1 offset:1024
  ds_read_b64_tr_b16 v[164:165], v5 offset:0
  ds_read_b64_tr_b16 v[166:167], v5 offset:1024
  s_waitcnt vmcnt(26)
  s_waitcnt lgkmcnt(12)
  v_mfma_f32_32x32x16_bf16 v[192:207], v[136:139], v[40:43], v[192:207]
  v_mfma_f32_32x32x16_bf16 v[224:239], v[140:143], v[40:43], v[224:239]
  v_mfma_f32_32x32x16_bf16 v[208:223], v[136:139], v[44:47], v[208:223]
  v_mfma_f32_32x32x16_bf16 v[240:255], v[140:143], v[44:47], v[240:255]
  ds_read_b64_tr_b16 v[168:169], v1 offset:2048
  ds_read_b64_tr_b16 v[170:171], v1 offset:3072
  ds_read_b64_tr_b16 v[172:173], v5 offset:2048
  ds_read_b64_tr_b16 v[174:175], v5 offset:3072
  s_waitcnt vmcnt(24)
  s_waitcnt lgkmcnt(12)
  v_mfma_f32_32x32x16_bf16 v[192:207], v[144:147], v[48:51], v[192:207]
  v_mfma_f32_32x32x16_bf16 v[224:239], v[148:151], v[48:51], v[224:239]
  v_mfma_f32_32x32x16_bf16 v[208:223], v[144:147], v[52:55], v[208:223]
  v_mfma_f32_32x32x16_bf16 v[240:255], v[148:151], v[52:55], v[240:255]
  v_add_u32 v1, 131072, v2
  v_xor_b32 v5, 64, v1
  ds_read_b64_tr_b16 v[176:177], v1 offset:0
  ds_read_b64_tr_b16 v[178:179], v1 offset:1024
  ds_read_b64_tr_b16 v[180:181], v5 offset:0
  ds_read_b64_tr_b16 v[182:183], v5 offset:1024
  s_waitcnt vmcnt(22)
  s_waitcnt lgkmcnt(12)
  v_mfma_f32_32x32x16_bf16 v[192:207], v[152:155], v[56:59], v[192:207]
  v_mfma_f32_32x32x16_bf16 v[224:239], v[156:159], v[56:59], v[224:239]
  v_mfma_f32_32x32x16_bf16 v[208:223], v[152:155], v[60:63], v[208:223]
  v_mfma_f32_32x32x16_bf16 v[240:255], v[156:159], v[60:63], v[240:255]
  ds_read_b64_tr_b16 v[184:185], v1 offset:2048
  ds_read_b64_tr_b16 v[186:187], v1 offset:3072
  ds_read_b64_tr_b16 v[188:189], v5 offset:2048
  ds_read_b64_tr_b16 v[190:191], v5 offset:3072
  s_waitcnt vmcnt(20)
  s_waitcnt lgkmcnt(12)
  v_mfma_f32_32x32x16_bf16 v[192:207], v[160:163], v[64:67], v[192:207]
  v_mfma_f32_32x32x16_bf16 v[224:239], v[164:167], v[64:67], v[224:239]
  v_mfma_f32_32x32x16_bf16 v[208:223], v[160:163], v[68:71], v[208:223]
  v_mfma_f32_32x32x16_bf16 v[240:255], v[164:167], v[68:71], v[240:255]
  v_add_u32 v1, 32768, v2
  v_xor_b32 v5, 64, v1
  ds_read_b64_tr_b16 v[128:129], v1 offset:0
  ds_read_b64_tr_b16 v[130:131], v1 offset:1024
  ds_read_b64_tr_b16 v[132:133], v5 offset:0
  ds_read_b64_tr_b16 v[134:135], v5 offset:1024
  s_waitcnt vmcnt(18)
  s_waitcnt lgkmcnt(12)
  v_mfma_f32_32x32x16_bf16 v[192:207], v[168:171], v[72:75], v[192:207]
  v_mfma_f32_32x32x16_bf16 v[224:239], v[172:175], v[72:75], v[224:239]
  v_mfma_f32_32x32x16_bf16 v[208:223], v[168:171], v[76:79], v[208:223]
  v_mfma_f32_32x32x16_bf16 v[240:255], v[172:175], v[76:79], v[240:255]
  ds_read_b64_tr_b16 v[136:137], v1 offset:2048
  ds_read_b64_tr_b16 v[138:139], v1 offset:3072
  ds_read_b64_tr_b16 v[140:141], v5 offset:2048
  ds_read_b64_tr_b16 v[142:143], v5 offset:3072
  s_waitcnt vmcnt(16)
  s_waitcnt lgkmcnt(12)
  v_mfma_f32_32x32x16_bf16 v[192:207], v[176:179], v[80:83], v[192:207]
  v_mfma_f32_32x32x16_bf16 v[224:239], v[180:183], v[80:83], v[224:239]
  v_mfma_f32_32x32x16_bf16 v[208:223], v[176:179], v[84:87], v[208:223]
  v_mfma_f32_32x32x16_bf16 v[240:255], v[180:183], v[84:87], v[240:255]
  v_mov_b32 v14, s86
  ds_write_b32 v14, v11 offset:16
  s_waitcnt lgkmcnt(0)
  s_waitcnt vmcnt(10)
  v_add_u32 v1, 81920, v2
  v_xor_b32 v5, 64, v1
  ds_read_b64_tr_b16 v[144:145], v1 offset:0
  ds_read_b64_tr_b16 v[146:147], v1 offset:1024
  ds_read_b64_tr_b16 v[148:149], v5 offset:0
  ds_read_b64_tr_b16 v[150:151], v5 offset:1024
  s_waitcnt lgkmcnt(12)
  v_mfma_f32_32x32x16_bf16 v[192:207], v[184:187], v[88:91], v[192:207]
  v_mfma_f32_32x32x16_bf16 v[224:239], v[188:191], v[88:91], v[224:239]
  v_mfma_f32_32x32x16_bf16 v[208:223], v[184:187], v[92:95], v[208:223]
  v_mfma_f32_32x32x16_bf16 v[240:255], v[188:191], v[92:95], v[240:255]
  ds_read_b64_tr_b16 v[152:153], v1 offset:2048
  ds_read_b64_tr_b16 v[154:155], v1 offset:3072
  ds_read_b64_tr_b16 v[156:157], v5 offset:2048
  ds_read_b64_tr_b16 v[158:159], v5 offset:3072
  s_waitcnt vmcnt(8)
  s_waitcnt lgkmcnt(12)
  v_mfma_f32_32x32x16_bf16 v[192:207], v[128:131], v[96:99], v[192:207]
  v_mfma_f32_32x32x16_bf16 v[224:239], v[132:135], v[96:99], v[224:239]
  v_mfma_f32_32x32x16_bf16 v[208:223], v[128:131], v[100:103], v[208:223]
  v_mfma_f32_32x32x16_bf16 v[240:255], v[132:135], v[100:103], v[240:255]
  s_waitcnt vmcnt(6)
  s_waitcnt lgkmcnt(8)
  v_mfma_f32_32x32x16_bf16 v[192:207], v[136:139], v[104:107], v[192:207]
  v_mfma_f32_32x32x16_bf16 v[224:239], v[140:143], v[104:107], v[224:239]
  v_mfma_f32_32x32x16_bf16 v[208:223], v[136:139], v[108:111], v[208:223]
  v_mfma_f32_32x32x16_bf16 v[240:255], v[140:143], v[108:111], v[240:255]
  s_waitcnt vmcnt(4)
  s_waitcnt lgkmcnt(4)
  v_mfma_f32_32x32x16_bf16 v[192:207], v[144:147], v[112:115], v[192:207]
  v_mfma_f32_32x32x16_bf16 v[224:239], v[148:151], v[112:115], v[224:239]
  v_mfma_f32_32x32x16_bf16 v[208:223], v[144:147], v[116:119], v[208:223]
  v_mfma_f32_32x32x16_bf16 v[240:255], v[148:151], v[116:119], v[240:255]
  s_waitcnt vmcnt(2)
  s_waitcnt lgkmcnt(0)
  v_mfma_f32_32x32x16_bf16 v[192:207], v[152:155], v[120:123], v[192:207]
  v_mfma_f32_32x32x16_bf16 v[224:239], v[156:159], v[120:123], v[224:239]
  v_mfma_f32_32x32x16_bf16 v[208:223], v[152:155], v[124:127], v[208:223]
  v_mfma_f32_32x32x16_bf16 v[240:255], v[156:159], v[124:127], v[240:255]
g2_r2_chk:
  v_mov_b32 v14, v6
  v_mov_b32 v15, v7
  v_max_u32 v14, v14, v15
  v_cmp_eq_u32 vcc, -1, v14
  s_nop 1
  s_cbranch_vccnz g2_r2_stub
g2_r2_ok:
  s_nop 7
  v_mul_f32 v192, v192, v6
  v_mul_f32 v193, v193, v6
  v_mul_f32 v194, v194, v6
  v_mul_f32 v195, v195, v6
  v_mul_f32 v196, v196, v6
  v_mul_f32 v197, v197, v6
  v_mul_f32 v198, v198, v6
  v_mul_f32 v199, v199, v6
  v_mul_f32 v200, v200, v6
  v_mul_f32 v201, v201, v6
  v_mul_f32 v202, v202, v6
  v_mul_f32 v203, v203, v6
  v_mul_f32 v204, v204, v6
  v_mul_f32 v205, v205, v6
  v_mul_f32 v206, v206, v6
  v_mul_f32 v207, v207, v6
  v_mul_f32 v208, v208, v7
  v_mul_f32 v209, v209, v7
  v_mul_f32 v210, v210, v7
  v_mul_f32 v211, v211, v7
  v_mul_f32 v212, v212, v7
  v_mul_f32 v213, v213, v7
  v_mul_f32 v214, v214, v7
  v_mul_f32 v215, v215, v7
  v_mul_f32 v216, v216, v7
  v_mul_f32 v217, v217, v7
  v_mul_f32 v218, v218, v7
  v_mul_f32 v219, v219, v7
  v_mul_f32 v220, v220, v7
  v_mul_f32 v221, v221, v7
  v_mul_f32 v222, v222, v7
  v_mul_f32 v223, v223, v7
  v_mul_f32 v224, v224, v6
  v_mul_f32 v225, v225, v6
  v_mul_f32 v226, v226, v6
  v_mul_f32 v227, v227, v6
  v_mul_f32 v228, v228, v6
  v_mul_f32 v229, v229, v6
  v_mul_f32 v230, v230, v6
  v_mul_f32 v231, v231, v6
  v_mul_f32 v232, v232, v6
  v_mul_f32 v233, v233, v6
  v_mul_f32 v234, v234, v6
  v_mul_f32 v235, v235, v6
  v_mul_f32 v236, v236, v6
  v_mul_f32 v237, v237, v6
  v_mul_f32 v238, v238, v6
  v_mul_f32 v239, v239, v6
  v_mul_f32 v240, v240, v7
  v_mul_f32 v241, v241, v7
  v_mul_f32 v242, v242, v7
  v_mul_f32 v243, v243, v7
  v_mul_f32 v244, v244, v7
  v_mul_f32 v245, v245, v7
  v_mul_f32 v246, v246, v7
  v_mul_f32 v247, v247, v7
  v_mul_f32 v248, v248, v7
  v_mul_f32 v249, v249, v7
  v_mul_f32 v250, v250, v7
  v_mul_f32 v251, v251, v7
  v_mul_f32 v252, v252, v7
  v_mul_f32 v253, v253, v7
  v_mul_f32 v254, v254, v7
  v_mul_f32 v255, v255, v7
  s_add_u32 s82, s87, 81920
  s_add_u32 s83, s87, 49152
  s_add_u32 s84, s87, 65536
  s_add_u32 s85, s87, 131072
  s_branch g2_red
gemm2h:
  s_lshl_b32 s87, s64, 12
  s_lshl_b32 s86, s64, 2
  s_add_u32 s86, s86, 155712
  v_lshrrev_b32 v5, 5, v0
  v_and_b32 v4, 31, v0
  v_lshlrev_b32 v3, 4, v0
  s_mul_i32 s65, s64, 56
  v_lshlrev_b32 v8, 2, v5
  v_add_u32 v8, s65, v8
  v_cmp_eq_u32 s[80:81], 0, v8
  v_cvt_f32_u32 v8, v8
  s_lshl_b32 s75, s61, 6
  v_add_u32 v9, s75, v4
  v_lshlrev_b32 v12, 31, v9
  v_xor_b32 v12, 0.5, v12
  v_cvt_f32_u32 v9, v9
  v_mov_b32 v30, 1
  s_waitcnt vmcnt(0)
  buffer_store_dword v30, v28, s[40:43], 0 offen sc0 sc1
  v_mov_b32 v14, s86
  ds_write_b32 v14, v30 offset:32
  v_mul_f32 v10, 0x3b124925, v9
  v_add_f32 v11, 0x00000000, v8
  v_mul_f32 v11, v11, v10
  v_cos_f32 v14, v11
  v_sin_f32 v15, v11
  v_add_f32 v11, v11, v10
  v_cndmask_b32 v14, v14, 0.5, s[80:81]
  v_cndmask_b32 v15, v15, v12, s[80:81]
  v_cvt_pk_bf16_f32 v72, v14, v15
  v_cos_f32 v14, v11
  v_sin_f32 v15, v11
  v_add_f32 v11, v11, v10
  v_cvt_pk_bf16_f32 v73, v14, v15
  v_cos_f32 v14, v11
  v_sin_f32 v15, v11
  v_add_f32 v11, v11, v10
  v_cvt_pk_bf16_f32 v74, v14, v15
  v_cos_f32 v14, v11
  v_sin_f32 v15, v11
  v_add_f32 v11, v11, v10
  v_cvt_pk_bf16_f32 v75, v14, v15
  v_add_f32 v11, 0x41000000, v8
  v_mul_f32 v11, v11, v10
  v_cos_f32 v14, v11
  v_sin_f32 v15, v11
  v_add_f32 v11, v11, v10
  v_cvt_pk_bf16_f32 v80, v14, v15
  v_cos_f32 v14, v11
  v_sin_f32 v15, v11
  v_add_f32 v11, v11, v10
  v_cvt_pk_bf16_f32 v81, v14, v15
  v_cos_f32 v14, v11
  v_sin_f32 v15, v11
  v_add_f32 v11, v11, v10
  v_cvt_pk_bf16_f32 v82, v14, v15
  v_cos_f32 v14, v11
  v_sin_f32 v15, v11
  v_add_f32 v11, v11, v10
  v_cvt_pk_bf16_f32 v83, v14, v15
  v_add_f32 v11, 0x41800000, v8
  v_mul_f32 v11, v11, v10
  v_cos_f32 v14, v11
  v_sin_f32 v15, v11
  v_add_f32 v11, v11, v10
  v_cvt_pk_bf16_f32 v88, v14, v15
  v_cos_f32 v14, v11
  v_sin_f32 v15, v11
  v_add_f32 v11, v11, v10
  v_cvt_pk_bf16_f32 v89, v14, v15
  v_cos_f32 v14, v11
  v_sin_f32 v15, v11
  v_add_f32 v11, v11, v10
  v_cvt_pk_bf16_f32 v90, v14, v15
  v_cos_f32 v14, v11
  v_sin_f32 v15, v11
  v_add_f32 v11, v11, v10
  v_cvt_pk_bf16_f32 v91, v14, v15
  v_add_f32 v11, 0x41c00000, v8
  v_mul_f32 v11, v11, v10
  v_cos_f32 v14, v11
  v_sin_f32 v15, v11
  v_add_f32 v11, v11, v10
  v_cvt_pk_bf16_f32 v96, v14, v15
  v_cos_f32 v14, v11
  v_sin_f32 v15, v11
  v_add_f32 v11, v11, v10
  v_cvt_pk_bf16_f32 v97, v14, v15
  v_cos_f32 v14, v11
  v_sin_f32 v15, v11
  v_add_f32 v11, v11, v10
  v_cvt_pk_bf16_f32 v98, v14, v15
  v_cos_f32 v14, v11
  v_sin_f32 v15, v11
  v_add_f32 v11, v11, v10
  v_cvt_pk_bf16_f32 v99, v14, v15
  v_add_f32 v11, 0x42000000, v8
  v_mul_f32 v11, v11, v10
  v_cos_f32 v14, v11
  v_sin_f32 v15, v11
  v_add_f32 v11, v11, v10
  v_cvt_pk_bf16_f32 v104, v14, v15
  v_cos_f32 v14, v11
  v_sin_f32 v15, v11
  v_add_f32 v11, v11, v10
  v_cvt_pk_bf16_f32 v105, v14, v15
  v_cos_f32 v14, v11
  v_sin_f32 v15, v11
  v_add_f32 v11, v11, v10
  v_cvt_pk_bf16_f32 v106, v14, v15
  v_cos_f32 v14, v11
  v_sin_f32 v15, v11
  v_add_f32 v11, v11, v10
  v_cvt_pk_bf16_f32 v107, v14, v15
  v_add_f32 v11, 0x42200000, v8
  v_mul_f32 v11, v11, v10
  v_cos_f32 v14, v11
  v_sin_f32 v15, v11
  v_add_f32 v11, v11, v10
  v_cvt_pk_bf16_f32 v112, v14, v15
  v_cos_f32 v14, v11
  v_sin_f32 v15, v11
  v_add_f32 v11, v11, v10
  v_cvt_pk_bf16_f32 v113, v14, v15
  v_cos_f32 v14, v11
  v_sin_f32 v15, v11
  v_add_f32 v11, v11, v10
  v_cvt_pk_bf16_f32 v114, v14, v15
  v_cos_f32 v14, v11
  v_sin_f32 v15, v11
  v_add_f32 v11, v11, v10
  v_cvt_pk_bf16_f32 v115, v14, v15
  v_add_f32 v11, 0x42400000, v8
  v_mul_f32 v11, v11, v10
  v_cos_f32 v14, v11
  v_sin_f32 v15, v11
  v_add_f32 v11, v11, v10
  v_cvt_pk_bf16_f32 v120, v14, v15
  v_cos_f32 v14, v11
  v_sin_f32 v15, v11
  v_add_f32 v11, v11, v10
  v_cvt_pk_bf16_f32 v121, v14, v15
  v_cos_f32 v14, v11
  v_sin_f32 v15, v11
  v_add_f32 v11, v11, v10
  v_cvt_pk_bf16_f32 v122, v14, v15
  v_cos_f32 v14, v11
  v_sin_f32 v15, v11
  v_add_f32 v11, v11, v10
  v_cvt_pk_bf16_f32 v123, v14, v15
  v_add_f32 v9, 0x42000000, v9
  v_mul_f32 v10, 0x3b124925, v9
  v_add_f32 v11, 0x00000000, v8
  v_mul_f32 v11, v11, v10
  v_cos_f32 v14, v11
  v_sin_f32 v15, v11
  v_add_f32 v11, v11, v10
  v_cndmask_b32 v14, v14, 0.5, s[80:81]
  v_cndmask_b32 v15, v15, v12, s[80:81]
  v_cvt_pk_bf16_f32 v76, v14, v15
  v_cos_f32 v14, v11
  v_sin_f32 v15, v11
  v_add_f32 v11, v11, v10
  v_cvt_pk_bf16_f32 v77, v14, v15
  v_cos_f32 v14, v11
  v_sin_f32 v15, v11
  v_add_f32 v11, v11, v10
  v_cvt_pk_bf16_f32 v78, v14, v15
  v_cos_f32 v14, v11
  v_sin_f32 v15, v11
  v_add_f32 v11, v11, v10
  v_cvt_pk_bf16_f32 v79, v14, v15
  v_add_f32 v11, 0x41000000, v8
  v_mul_f32 v11, v11, v10
  v_cos_f32 v14, v11
  v_sin_f32 v15, v11
  v_add_f32 v11, v11, v10
  v_cvt_pk_bf16_f32 v84, v14, v15
  v_cos_f32 v14, v11
  v_sin_f32 v15, v11
  v_add_f32 v11, v11, v10
  v_cvt_pk_bf16_f32 v85, v14, v15
  v_cos_f32 v14, v11
  v_sin_f32 v15, v11
  v_add_f32 v11, v11, v10
  v_cvt_pk_bf16_f32 v86, v14, v15
  v_cos_f32 v14, v11
  v_sin_f32 v15, v11
  v_add_f32 v11, v11, v10
  v_cvt_pk_bf16_f32 v87, v14, v15
  v_add_f32 v11, 0x41800000, v8
  v_mul_f32 v11, v11, v10
  v_cos_f32 v14, v11
  v_sin_f32 v15, v11
  v_add_f32 v11, v11, v10
  v_cvt_pk_bf16_f32 v92, v14, v15
  v_cos_f32 v14, v11
  v_sin_f32 v15, v11
  v_add_f32 v11, v11, v10
  v_cvt_pk_bf16_f32 v93, v14, v15
  v_cos_f32 v14, v11
  v_sin_f32 v15, v11
  v_add_f32 v11, v11, v10
  v_cvt_pk_bf16_f32 v94, v14, v15
  v_cos_f32 v14, v11
  v_sin_f32 v15, v11
  v_add_f32 v11, v11, v10
  v_cvt_pk_bf16_f32 v95, v14, v15
  v_add_f32 v11, 0x41c00000, v8
  v_mul_f32 v11, v11, v10
  v_cos_f32 v14, v11
  v_sin_f32 v15, v11
  v_add_f32 v11, v11, v10
  v_cvt_pk_bf16_f32 v100, v14, v15
  v_cos_f32 v14, v11
  v_sin_f32 v15, v11
  v_add_f32 v11, v11, v10
  v_cvt_pk_bf16_f32 v101, v14, v15
  v_cos_f32 v14, v11
  v_sin_f32 v15, v11
  v_add_f32 v11, v11, v10
  v_cvt_pk_bf16_f32 v102, v14, v15
  v_cos_f32 v14, v11
  v_sin_f32 v15, v11
  v_add_f32 v11, v11, v10
  v_cvt_pk_bf16_f32 v103, v14, v15
  v_add_f32 v11, 0x42000000, v8
  v_mul_f32 v11, v11, v10
  v_cos_f32 v14, v11
  v_sin_f32 v15, v11
  v_add_f32 v11, v11, v10
  v_cvt_pk_bf16_f32 v108, v14, v15
  v_cos_f32 v14, v11
  v_sin_f32 v15, v11
  v_add_f32 v11, v11, v10
  v_cvt_pk_bf16_f32 v109, v14, v15
  v_cos_f32 v14, v11
  v_sin_f32 v15, v11
  v_add_f32 v11, v11, v10
  v_cvt_pk_bf16_f32 v110, v14, v15
  v_cos_f32 v14, v11
  v_sin_f32 v15, v11
  v_add_f32 v11, v11, v10
  v_cvt_pk_bf16_f32 v111, v14, v15
  v_add_f32 v11, 0x42200000, v8
  v_mul_f32 v11, v11, v10
  v_cos_f32 v14, v11
  v_sin_f32 v15, v11
  v_add_f32 v11, v11, v10
  v_cvt_pk_bf16_f32 v116, v14, v15
  v_cos_f32 v14, v11
  v_sin_f32 v15, v11
  v_add_f32 v11, v11, v10
  v_cvt_pk_bf16_f32 v117, v14, v15
  v_cos_f32 v14, v11
  v_sin_f32 v15, v11
  v_add_f32 v11, v11, v10
  v_cvt_pk_bf16_f32 v118, v14, v15
  v_cos_f32 v14, v11
  v_sin_f32 v15, v11
  v_add_f32 v11, v11, v10
  v_cvt_pk_bf16_f32 v119, v14, v15
  v_add_f32 v11, 0x42400000, v8
  v_mul_f32 v11, v11, v10
  v_cos_f32 v14, v11
  v_sin_f32 v15, v11
  v_add_f32 v11, v11, v10
  v_cvt_pk_bf16_f32 v124, v14, v15
  v_cos_f32 v14, v11
  v_sin_f32 v15, v11
  v_add_f32 v11, v11, v10
  v_cvt_pk_bf16_f32 v125, v14, v15
  v_cos_f32 v14, v11
  v_sin_f32 v15, v11
  v_add_f32 v11, v11, v10
  v_cvt_pk_bf16_f32 v126, v14, v15
  v_cos_f32 v14, v11
  v_sin_f32 v15, v11
  v_add_f32 v11, v11, v10
  v_cvt_pk_bf16_f32 v127, v14, v15
  s_mov_b32 s48, s18
  s_mov_b32 s49, s19
  s_mov_b32 s50, 1835008
  s_mov_b32 s51, 0x00020000
  s_lshr_b32 s65, s3, 1
  s_and_b32 s76, s65, 1
  s_lshl_b32 s76, s76, 2
  s_lshr_b32 s78, s60, 1
  s_lshl_b32 s78, s78, 3
  s_add_u32 s76, s76, s78
  s_and_b32 s78, s60, 1
  s_add_u32 s76, s76, s78
  s_mul_i32 s76, s76, 14336
  s_lshr_b32 s65, s65, 1
  s_lshl_b32 s78, s61, 1
  s_add_u32 s78, s78, s65
  s_lshl_b32 s78, s78, 6
  s_add_u32 s76, s76, s78
  s_and_b32 s78, s3, 1
  s_lshl_b32 s78, s78, 5
  s_add_u32 s76, s76, s78
  v_and_b32 v12, 15, v0
  v_bfe_u32 v13, v0, 4, 1
  v_lshl_add_u32 v12, v13, 5, v12
  v_mul_u32_u24 v12, 896, v12
  v_lshrrev_b32 v14, 5, v0
  v_lshl_add_u32 v13, v14, 3, v12
  v_lshl_add_u32 v12, v14, 4, v12
  v_and_b32 v10, 15, v0
  v_lshlrev_b32 v10, 4, v10
  v_bfe_u32 v11, v0, 4, 1
  v_lshl_add_u32 v11, v5, 2, v11
  v_mul_u32_u24 v8, 8448, v11
  v_add_u32 v8, v8, v10
  v_add_u32 v9, 16896, v8
  s_mul_i32 s74, s64, 473088
  s_lshl_b32 s75, s60, 8
  s_add_u32 s74, s74, s75
  s_add_u32 s75, s75, 1892352
  s_cmp_eq_u32 s64, 0
  s_cselect_b32 s75, s75, 0x40000000
  s_cselect_b32 s65, 16, 0
  v_cmp_gt_u32 vcc, s65, v0
  v_mov_b32 v11, 0x40000000
  s_nop 0
  v_cndmask_b32 v10, v11, v10, vcc
  v_mov_b32 v11, -1
  v_mov_b32 v14, 0xffff
  v_cndmask_b32 v11, v11, v14, vcc
  s_mul_i32 s65, s64, 224
  s_cmp_eq_u32 s64, 0
  s_cselect_b32 s73, 896, s65
  v_lshlrev_b32 v15, 2, v0
  v_add_u32 v15, s65, v15
  v_mov_b32 v14, s73
  v_cmp_gt_u32 vcc, 56, v0
  s_nop 1
  v_cndmask_b32 v15, v14, v15, vcc
  s_lshl_b32 s65, s60, 10
  s_add_u32 s65, s65, 24576
  v_add_u32 v15, s65, v15
  s_add_u32 s82, s87, 98304
  s_add_u32 s83, s87, 114688
  s_add_u32 s84, s87, 0
  s_add_u32 s85, s87, 16384
  buffer_load_dwordx2 v[16:17], v13, s[24:27], s76 offen offset:0
  buffer_load_dwordx2 v[18:19], v13, s[24:27], s76 offen offset:16
  s_mov_b32 s77, 20000
  s_branch fz_ld
fz_pl:
  v_cmp_ne_u32 vcc, 1, v14
  s_nop 1
  s_cbranch_vccz fz_ok
  s_sub_u32 s77, s77, 1
  s_cbranch_scc1 fz_ok
  s_sub_u32 s79, s79, 0
  s_sleep 4
fz_ld:
  buffer_load_dword v14, v15, s[40:43], 0 offen sc1
  s_waitcnt vmcnt(0)
  s_branch fz_pl
fz_ok:
  s_add_u32 s65, s74, 0
  buffer_load_dwordx4 v[128:131], v8, s[44:47], s65 offen
  buffer_load_dwordx4 v[132:135], v9, s[44:47], s65 offen
  buffer_load_dwordx4 v[184:187], v10, s[44:47], s75 offen
  s_add_u32 s65, s74, 67584
  buffer_load_dwordx4 v[136:139], v8, s[44:47], s65 offen
  buffer_load_dwordx4 v[140:143], v9, s[44:47], s65 offen
  s_add_u32 s65, s74, 135168
  buffer_load_dwordx4 v[144:147], v8, s[44:47], s65 offen
  buffer_load_dwordx4 v[148:151], v9, s[44:47], s65 offen
  s_add_u32 s65, s74, 202752
  buffer_load_dwordx4 v[152:155], v8, s[44:47], s65 offen
  buffer_load_dwordx4 v[156:159], v9, s[44:47], s65 offen
  s_add_u32 s65, s74, 270336
  buffer_load_dwordx4 v[160:163], v8, s[44:47], s65 offen
  buffer_load_dwordx4 v[164:167], v9, s[44:47], s65 offen
  s_add_u32 s65, s74, 337920
  buffer_load_dwordx4 v[168:171], v8, s[44:47], s65 offen
  buffer_load_dwordx4 v[172:175], v9, s[44:47], s65 offen
  s_add_u32 s65, s74, 405504
  buffer_load_dwordx4 v[176:179], v8, s[44:47], s65 offen
  buffer_load_dwordx4 v[180:183], v9, s[44:47], s65 offen
  s_waitcnt vmcnt(12)
  v_and_b32 v128, v128, v11
  v_lshl_or_b32 v128, v184, 16, v128
  v_and_b32 v129, v129, v11
  v_lshl_or_b32 v129, v185, 16, v129
  v_and_b32 v130, v130, v11
  v_lshl_or_b32 v130, v186, 16, v130
  v_and_b32 v131, v131, v11
  v_lshl_or_b32 v131, v187, 16, v131
  v_permlane16_swap_b32 v128, v129
  s_nop 0
  v_permlane16_swap_b32 v130, v131
  v_permlane16_swap_b32 v132, v133
  v_permlane16_swap_b32 v134, v135
  v_swap_b32 v130, v132
  v_swap_b32 v131, v133
  s_nop 1
  v_mfma_f32_32x32x16_bf16 v[192:207], v[72:75], v[128:131], 0
  v_mfma_f32_32x32x16_bf16 v[224:239], v[76:79], v[128:131], 0
  v_mfma_f32_32x32x16_bf16 v[208:223], v[72:75], v[132:135], 0
  v_mfma_f32_32x32x16_bf16 v[240:255], v[76:79], v[132:135], 0
  s_waitcnt vmcnt(10)
  v_permlane16_swap_b32 v136, v137
  v_permlane16_swap_b32 v138, v139
  v_permlane16_swap_b32 v140, v141
  v_permlane16_swap_b32 v142, v143
  v_swap_b32 v138, v140
  v_swap_b32 v139, v141
  s_nop 1
  v_mfma_f32_32x32x16_bf16 v[192:207], v[80:83], v[136:139], v[192:207]
  v_mfma_f32_32x32x16_bf16 v[224:239], v[84:87], v[136:139], v[224:239]
  v_mfma_f32_32x32x16_bf16 v[208:223], v[80:83], v[140:143], v[208:223]
  v_mfma_f32_32x32x16_bf16 v[240:255], v[84:87], v[140:143], v[240:255]
  s_waitcnt vmcnt(8)
  v_permlane16_swap_b32 v144, v145
  v_permlane16_swap_b32 v146, v147
  v_permlane16_swap_b32 v148, v149
  v_permlane16_swap_b32 v150, v151
  v_swap_b32 v146, v148
  v_swap_b32 v147, v149
  s_nop 1
  v_mfma_f32_32x32x16_bf16 v[192:207], v[88:91], v[144:147], v[192:207]
  v_mfma_f32_32x32x16_bf16 v[224:239], v[92:95], v[144:147], v[224:239]
  v_mfma_f32_32x32x16_bf16 v[208:223], v[88:91], v[148:151], v[208:223]
  v_mfma_f32_32x32x16_bf16 v[240:255], v[92:95], v[148:151], v[240:255]
  s_waitcnt vmcnt(6)
  v_permlane16_swap_b32 v152, v153
  v_permlane16_swap_b32 v154, v155
  v_permlane16_swap_b32 v156, v157
  v_permlane16_swap_b32 v158, v159
  v_swap_b32 v154, v156
  v_swap_b32 v155, v157
  s_nop 1
  v_mfma_f32_32x32x16_bf16 v[192:207], v[96:99], v[152:155], v[192:207]
  v_mfma_f32_32x32x16_bf16 v[224:239], v[100:103], v[152:155], v[224:239]
  v_mfma_f32_32x32x16_bf16 v[208:223], v[96:99], v[156:159], v[208:223]
  v_mfma_f32_32x32x16_bf16 v[240:255], v[100:103], v[156:159], v[240:255]
  s_waitcnt vmcnt(4)
  v_permlane16_swap_b32 v160, v161
  v_permlane16_swap_b32 v162, v163
  v_permlane16_swap_b32 v164, v165
  v_permlane16_swap_b32 v166, v167
  v_swap_b32 v162, v164
  v_swap_b32 v163, v165
  s_nop 1
  v_mfma_f32_32x32x16_bf16 v[192:207], v[104:107], v[160:163], v[192:207]
  v_mfma_f32_32x32x16_bf16 v[224:239], v[108:111], v[160:163], v[224:239]
  v_mfma_f32_32x32x16_bf16 v[208:223], v[104:107], v[164:167], v[208:223]
  v_mfma_f32_32x32x16_bf16 v[240:255], v[108:111], v[164:167], v[240:255]
  s_waitcnt vmcnt(2)
  v_permlane16_swap_b32 v168, v169
  v_permlane16_swap_b32 v170, v171
  v_permlane16_swap_b32 v172, v173
  v_permlane16_swap_b32 v174, v175
  v_swap_b32 v170, v172
  v_swap_b32 v171, v173
  s_nop 1
  v_mfma_f32_32x32x16_bf16 v[192:207], v[112:115], v[168:171], v[192:207]
  v_mfma_f32_32x32x16_bf16 v[224:239], v[116:119], v[168:171], v[224:239]
  v_mfma_f32_32x32x16_bf16 v[208:223], v[112:115], v[172:175], v[208:223]
  v_mfma_f32_32x32x16_bf16 v[240:255], v[116:119], v[172:175], v[240:255]
  s_waitcnt vmcnt(0)
  v_permlane16_swap_b32 v176, v177
  v_permlane16_swap_b32 v178, v179
  v_permlane16_swap_b32 v180, v181
  v_permlane16_swap_b32 v182, v183
  v_swap_b32 v178, v180
  v_swap_b32 v179, v181
  s_nop 1
  v_mfma_f32_32x32x16_bf16 v[192:207], v[120:123], v[176:179], v[192:207]
  v_mfma_f32_32x32x16_bf16 v[224:239], v[124:127], v[176:179], v[224:239]
  v_mfma_f32_32x32x16_bf16 v[208:223], v[120:123], v[180:183], v[208:223]
  v_mfma_f32_32x32x16_bf16 v[240:255], v[124:127], v[180:183], v[240:255]
  v_mov_b32 v14, s86
  s_mov_b32 s77, 400000
  s_branch g2_bf_1
g2_bf:
  s_sleep 1
g2_bf_1:
  ds_read_b32 v15, v14 offset:16
  s_waitcnt lgkmcnt(0)
  v_readfirstlane_b32 s73, v15
  s_sub_u32 s77, s77, 1
  s_cbranch_scc1 g2_bf_ok
  s_cmp_lt_u32 s73, 1
  s_cbranch_scc1 g2_bf
g2_bf_ok:
  s_nop 7
g2_red:
  v_add_u32 v8, s82, v3
  v_add_u32 v9, s83, v3
  v_add_u32 v10, s84, v3
  v_add_u32 v11, s85, v3
  ds_write_b128 v8, v[192:195] offset:0
  ds_write_b128 v8, v[196:199] offset:1024
  ds_write_b128 v8, v[200:203] offset:2048
  ds_write_b128 v8, v[204:207] offset:3072
  ds_write_b128 v9, v[208:211] offset:0
  ds_write_b128 v9, v[212:215] offset:1024
  ds_write_b128 v9, v[216:219] offset:2048
  ds_write_b128 v9, v[220:223] offset:3072
  ds_write_b128 v10, v[224:227] offset:0
  ds_write_b128 v10, v[228:231] offset:1024
  ds_write_b128 v10, v[232:235] offset:2048
  ds_write_b128 v10, v[236:239] offset:3072
  ds_write_b128 v11, v[240:243] offset:0
  ds_write_b128 v11, v[244:247] offset:1024
  ds_write_b128 v11, v[248:251] offset:2048
  ds_write_b128 v11, v[252:255] offset:3072
  s_lshr_b32 s65, s3, 1
  s_lshl_b32 s65, s65, 2
  s_lshr_b32 s66, 33845, s65
  s_and_b32 s66, s66, 15
  s_lshl_b32 s66, s66, 14
  s_lshr_b32 s67, 4214, s65
  s_and_b32 s67, s67, 15
  s_lshl_b32 s67, s67, 14
  s_and_b32 s65, s3, 1
  s_lshl_b32 s65, s65, 11
  s_add_u32 s66, s66, s65
  s_add_u32 s67, s67, s65
  v_add_u32 v2, s66, v3
  v_add_u32 v7, s67, v3
  s_waitcnt vmcnt(0)
  v_lshlrev_b32 v96, 16, v16
  v_and_b32 v97, 0xffff0000, v16
  v_lshlrev_b32 v98, 16, v17
  v_and_b32 v99, 0xffff0000, v17
  v_lshlrev_b32 v100, 16, v18
  v_and_b32 v101, 0xffff0000, v18
  v_lshlrev_b32 v102, 16, v19
  v_and_b32 v103, 0xffff0000, v19
  s_waitcnt lgkmcnt(0)
  s_barrier
  ds_read_b128 v[16:19], v2 offset:0
  ds_read_b128 v[20:23], v2 offset:1024
  ds_read_b128 v[24:27], v2 offset:4096
  ds_read_b128 v[28:31], v2 offset:5120
  ds_read_b128 v[32:35], v2 offset:8192
  ds_read_b128 v[36:39], v2 offset:9216
  ds_read_b128 v[40:43], v2 offset:12288
  ds_read_b128 v[44:47], v2 offset:13312
  ds_read_b128 v[48:51], v7 offset:0
  ds_read_b128 v[52:55], v7 offset:1024
  ds_read_b128 v[56:59], v7 offset:4096
  ds_read_b128 v[60:63], v7 offset:5120
  ds_read_b128 v[64:67], v7 offset:8192
  ds_read_b128 v[68:71], v7 offset:9216
  ds_read_b128 v[72:75], v7 offset:12288
  ds_read_b128 v[76:79], v7 offset:13312
  s_waitcnt lgkmcnt(14)
  v_pk_add_f32 v[96:97], v[96:97], v[16:17]
  v_pk_add_f32 v[98:99], v[98:99], v[18:19]
  v_pk_add_f32 v[100:101], v[100:101], v[20:21]
  v_pk_add_f32 v[102:103], v[102:103], v[22:23]
  s_waitcnt lgkmcnt(12)
  v_pk_add_f32 v[96:97], v[96:97], v[24:25]
  v_pk_add_f32 v[98:99], v[98:99], v[26:27]
  v_pk_add_f32 v[100:101], v[100:101], v[28:29]
  v_pk_add_f32 v[102:103], v[102:103], v[30:31]
  s_waitcnt lgkmcnt(10)
  v_pk_add_f32 v[96:97], v[96:97], v[32:33]
  v_pk_add_f32 v[98:99], v[98:99], v[34:35]
  v_pk_add_f32 v[100:101], v[100:101], v[36:37]
  v_pk_add_f32 v[102:103], v[102:103], v[38:39]
  s_waitcnt lgkmcnt(8)
  v_pk_add_f32 v[96:97], v[96:97], v[40:41]
  v_pk_add_f32 v[98:99], v[98:99], v[42:43]
  v_pk_add_f32 v[100:101], v[100:101], v[44:45]
  v_pk_add_f32 v[102:103], v[102:103], v[46:47]
  s_waitcnt lgkmcnt(6)
  v_pk_add_f32 v[96:97], v[96:97], v[48:49]
  v_pk_add_f32 v[98:99], v[98:99], v[50:51]
  v_pk_add_f32 v[100:101], v[100:101], v[52:53]
  v_pk_add_f32 v[102:103], v[102:103], v[54:55]
  s_waitcnt lgkmcnt(4)
  v_pk_add_f32 v[96:97], v[96:97], v[56:57]
  v_pk_add_f32 v[98:99], v[98:99], v[58:59]
  v_pk_add_f32 v[100:101], v[100:101], v[60:61]
  v_pk_add_f32 v[102:103], v[102:103], v[62:63]
  s_waitcnt lgkmcnt(2)
  v_pk_add_f32 v[96:97], v[96:97], v[64:65]
  v_pk_add_f32 v[98:99], v[98:99], v[66:67]
  v_pk_add_f32 v[100:101], v[100:101], v[68:69]
  v_pk_add_f32 v[102:103], v[102:103], v[70:71]
  s_waitcnt lgkmcnt(0)
  v_pk_add_f32 v[96:97], v[96:97], v[72:73]
  v_pk_add_f32 v[98:99], v[98:99], v[74:75]
  v_pk_add_f32 v[100:101], v[100:101], v[76:77]
  v_pk_add_f32 v[102:103], v[102:103], v[78:79]
  v_cvt_pk_bf16_f32 v112, v96, v97
  v_cvt_pk_bf16_f32 v113, v98, v99
  v_cvt_pk_bf16_f32 v114, v100, v101
  v_cvt_pk_bf16_f32 v115, v102, v103
  s_nop 0
  v_permlane32_swap_b32 v112, v114
  v_permlane32_swap_b32 v113, v115
  buffer_store_dwordx4 v[112:115], v12, s[48:51], s76 offen
  s_endpgm
g2_r2_stub:
  s_cmp_eq_u32 s79, 0
  s_cbranch_scc1 g2_r2_ok
  s_sub_u32 s79, s79, 1
  s_sleep 6
  buffer_load_dword v6, v10, s[52:55], s85 offen offset:0 sc1
  buffer_load_dword v7, v10, s[52:55], s85 offen offset:128 sc1
  s_waitcnt vmcnt(0)
  s_branch g2_r2_chk
dft_wg:
  s_sub_u32 s57, s57, 28
  s_lshr_b32 s59, s56, 1
  s_lshl_b32 s59, s59, 1
  s_and_b32 s65, s56, 1
  s_lshl_b32 s65, s65, 3
  s_add_u32 s59, s59, s65
  s_lshr_b32 s65, s57, 1
  s_add_u32 s59, s59, s65
  s_and_b32 s58, s57, 1
  s_lshl_b32 s60, s56, 2
  s_add_u32 s60, s60, s57
  s_lshl_b32 s65, s59, 3
  s_and_b32 s66, s3, 6
  s_add_u32 s65, s65, s66
  s_add_u32 s65, s65, s58
  s_mul_i32 s65, s65, 14336
  s_and_b32 s66, s3, 1
  s_cmp_eq_u32 s66, 1
  s_cselect_b64 vcc, -1, 0
  v_cndmask_b32 v12, v12, v13, vcc
  s_lshl_b32 s71, s3, 10
  v_lshrrev_b32 v3, 5, v0
  v_and_b32 v1, 31, v0
  s_cmp_eq_u32 s3, 7
  s_waitcnt lgkmcnt(0)
  s_cbranch_scc1 l1_clr
l1_ret:
  s_mov_b32 s24, s4
  s_mov_b32 s25, s5
  s_mov_b32 s26, 1835008
  s_mov_b32 s27, 0x00020000
  s_mov_b32 s73, s65
  s_add_u32 s67, s73, 0
  s_add_u32 m0, s71, 0
  s_nop 0
  buffer_load_dwordx4 v12, s[24:27], s67 offen lds
  s_add_u32 s67, s73, 128
  s_add_u32 m0, s71, 8192
  s_nop 0
  buffer_load_dwordx4 v12, s[24:27], s67 offen lds
  s_add_u32 s67, s73, 256
  s_add_u32 m0, s71, 16384
  s_nop 0
  buffer_load_dwordx4 v12, s[24:27], s67 offen lds
  s_add_u32 s67, s73, 384
  s_add_u32 m0, s71, 24576
  s_nop 0
  buffer_load_dwordx4 v12, s[24:27], s67 offen lds
  s_add_u32 s67, s73, 512
  s_add_u32 m0, s71, 32768
  s_nop 0
  buffer_load_dwordx4 v12, s[24:27], s67 offen lds
  s_add_u32 s67, s73, 640
  s_add_u32 m0, s71, 40960
  s_nop 0
  buffer_load_dwordx4 v12, s[24:27], s67 offen lds
  s_add_u32 s67, s73, 768
  s_add_u32 m0, s71, 49152
  s_nop 0
  buffer_load_dwordx4 v12, s[24:27], s67 offen lds
  s_add_u32 s44, s22, 7405568
  s_addc_u32 s45, s23, 0
  s_mov_b32 s46, 1949696
  s_mov_b32 s47, 0x00020000
  s_mov_b32 s79, 20000
  s_lshl_b32 s83, s59, 9
  s_lshl_b32 s69, s58, 8
  s_add_u32 s83, s83, s69
  v_lshlrev_b32 v2, 5, v1
  v_lshl_add_u32 v2, v3, 13, v2
  v_bfe_u32 v6, v0, 3, 1
  v_lshl_add_u32 v2, v6, 4, v2
  v_add_u32 v2, s71, v2
  v_xor_b32 v6, 16, v2
  s_mov_b32 s70, 0x05040100
  s_mov_b32 s71, 0x07060302
  s_cmp_eq_u32 s3, 7
  s_cbranch_scc1 dft_stat
  s_cmp_eq_u32 s3, 6
  s_cselect_b32 s67, 8192, 0x40000000
  v_mul_u32_u24 v8, 121856, v0
  buffer_load_dword v224, v8, s[44:47], s67 offen
  v_and_b32 v8, 15, v0
  v_lshlrev_b32 v8, 4, v8
  v_lshrrev_b32 v9, 4, v0
  v_mul_u32_u24 v10, 8704, v9
  v_add_u32 v10, v10, v8
  v_sub_u32 v11, 3, v9
  v_mul_u32_u24 v11, 8704, v11
  v_add_u32 v11, v11, v8
  s_lshl_b32 s65, s3, 4
  s_mul_i32 s84, s65, 8704
  s_add_u32 s84, s84, s83
  s_sub_u32 s66, 221, s65
  s_mul_i32 s66, s66, 8704
  s_add_u32 s86, s66, s83
  v_add_u32 v13, s66, v11
  v_add_u32 v8, 974848, v8
  s_cmp_eq_u32 s3, 0
  s_cselect_b32 s80, -1, 0
  s_mov_b32 s81, 0
  s_cselect_b32 s66, 16, 0
  v_cmp_gt_u32 vcc, s66, v0
  s_nop 1
  v_cndmask_b32 v13, v13, v8, vcc
  v_lshrrev_b32 v8, 1, v1
  v_add_u32 v8, s65, v8
  v_and_b32 v9, 1, v1
  v_cvt_f32_u32 v14, v9
  v_mul_f32 v14, 0x3e800000, v14
  v_cmp_eq_u32 vcc, 1, v1
  s_cmp_eq_u32 s3, 0
  s_cselect_b64 vcc, vcc, 0
  v_mov_b32 v9, 112
  v_cndmask_b32 v8, v8, v9, vcc
  v_cndmask_b32 v15, v14, 0, vcc
  v_cvt_f32_u32 v8, v8
  v_mul_f32 v8, 0x3b124925, v8
  v_mul_f32 v9, 0x42000000, v8
  v_cos_f32 v4, v9
  s_nop 0
  v_add_f32 v4, v4, v4
  v_lshlrev_b32 v16, 4, v3
  v_cvt_f32_u32 v16, v16
  v_fma_f32 v15, v16, v8, v15
  v_fma_f32 v14, v16, v8, v14
  v_add_f32 v14, v14, v8
  v_add_f32 v16, v8, v8
  s_mov_b32 s87, 0x05040100
  s_mov_b32 s78, 0x07060302
  v_sub_f32 v17, v15, v9
  v_cos_f32 v144, v15
  v_cos_f32 v160, v17
  v_add_f32 v15, v15, v16
  v_sub_f32 v17, v15, v9
  v_cos_f32 v145, v15
  v_cos_f32 v161, v17
  v_add_f32 v15, v15, v16
  v_sub_f32 v17, v15, v9
  v_cos_f32 v146, v15
  v_cos_f32 v162, v17
  v_add_f32 v15, v15, v16
  v_sub_f32 v17, v15, v9
  v_cos_f32 v147, v15
  v_cos_f32 v163, v17
  v_add_f32 v15, v15, v16
  v_sub_f32 v17, v15, v9
  v_cos_f32 v148, v15
  v_cos_f32 v164, v17
  v_add_f32 v15, v15, v16
  v_sub_f32 v17, v15, v9
  v_cos_f32 v149, v15
  v_cos_f32 v165, v17
  v_add_f32 v15, v15, v16
  v_sub_f32 v17, v15, v9
  v_cos_f32 v150, v15
  v_cos_f32 v166, v17
  v_add_f32 v15, v15, v16
  v_sub_f32 v17, v15, v9
  v_cos_f32 v151, v15
  v_cos_f32 v167, v17
  v_add_f32 v15, v15, v16
  v_sub_f32 v17, v14, v9
  v_cos_f32 v152, v14
  v_cos_f32 v168, v17
  v_add_f32 v14, v14, v16
  v_sub_f32 v17, v14, v9
  v_cos_f32 v153, v14
  v_cos_f32 v169, v17
  v_add_f32 v14, v14, v16
  v_sub_f32 v17, v14, v9
  v_cos_f32 v154, v14
  v_cos_f32 v170, v17
  v_add_f32 v14, v14, v16
  v_sub_f32 v17, v14, v9
  v_cos_f32 v155, v14
  v_cos_f32 v171, v17
  v_add_f32 v14, v14, v16
  v_sub_f32 v17, v14, v9
  v_cos_f32 v156, v14
  v_cos_f32 v172, v17
  v_add_f32 v14, v14, v16
  v_sub_f32 v17, v14, v9
  v_cos_f32 v157, v14
  v_cos_f32 v173, v17
  v_add_f32 v14, v14, v16
  v_sub_f32 v17, v14, v9
  v_cos_f32 v158, v14
  v_cos_f32 v174, v17
  v_add_f32 v14, v14, v16
  v_sub_f32 v17, v14, v9
  v_cos_f32 v159, v14
  v_cos_f32 v175, v17
  v_add_f32 v14, v14, v16
  v_mov_b32 v5, v4
  v_cvt_pk_bf16_f32 v176, v144, v145
  v_cvt_pk_bf16_f32 v177, v146, v147
  v_cvt_pk_bf16_f32 v178, v148, v149
  v_cvt_pk_bf16_f32 v179, v150, v151
  v_cvt_pk_bf16_f32 v180, v152, v153
  v_cvt_pk_bf16_f32 v181, v154, v155
  v_cvt_pk_bf16_f32 v182, v156, v157
  v_cvt_pk_bf16_f32 v183, v158, v159
  v_fma_f32 v160, v4, v144, -v160
  v_fma_f32 v161, v4, v145, -v161
  v_fma_f32 v162, v4, v146, -v162
  v_fma_f32 v163, v4, v147, -v163
  v_fma_f32 v164, v4, v148, -v164
  v_fma_f32 v165, v4, v149, -v165
  v_fma_f32 v166, v4, v150, -v166
  v_fma_f32 v167, v4, v151, -v167
  v_fma_f32 v168, v4, v152, -v168
  v_fma_f32 v169, v4, v153, -v169
  v_fma_f32 v170, v4, v154, -v170
  v_fma_f32 v171, v4, v155, -v171
  v_fma_f32 v172, v4, v156, -v172
  v_fma_f32 v173, v4, v157, -v173
  v_fma_f32 v174, v4, v158, -v174
  v_fma_f32 v175, v4, v159, -v175
  v_cvt_pk_bf16_f32 v184, v160, v161
  v_cvt_pk_bf16_f32 v185, v162, v163
  v_cvt_pk_bf16_f32 v186, v164, v165
  v_cvt_pk_bf16_f32 v187, v166, v167
  v_cvt_pk_bf16_f32 v188, v168, v169
  v_cvt_pk_bf16_f32 v189, v170, v171
  v_cvt_pk_bf16_f32 v190, v172, v173
  v_cvt_pk_bf16_f32 v191, v174, v175
  v_fma_f32 v144, v4, v160, -v144
  v_fma_f32 v145, v4, v161, -v145
  v_fma_f32 v146, v4, v162, -v146
  v_fma_f32 v147, v4, v163, -v147
  v_fma_f32 v148, v4, v164, -v148
  v_fma_f32 v149, v4, v165, -v149
  v_fma_f32 v150, v4, v166, -v150
  v_fma_f32 v151, v4, v167, -v151
  v_fma_f32 v152, v4, v168, -v152
  v_fma_f32 v153, v4, v169, -v153
  v_fma_f32 v154, v4, v170, -v154
  v_fma_f32 v155, v4, v171, -v155
  v_fma_f32 v156, v4, v172, -v156
  v_fma_f32 v157, v4, v173, -v157
  v_fma_f32 v158, v4, v174, -v158
  v_fma_f32 v159, v4, v175, -v159
  v_cvt_pk_bf16_f32 v192, v144, v145
  v_cvt_pk_bf16_f32 v193, v146, v147
  v_cvt_pk_bf16_f32 v194, v148, v149
  v_cvt_pk_bf16_f32 v195, v150, v151
  v_cvt_pk_bf16_f32 v196, v152, v153
  v_cvt_pk_bf16_f32 v197, v154, v155
  v_cvt_pk_bf16_f32 v198, v156, v157
  v_cvt_pk_bf16_f32 v199, v158, v159
  v_fma_f32 v160, v4, v144, -v160
  v_fma_f32 v161, v4, v145, -v161
  v_fma_f32 v162, v4, v146, -v162
  v_fma_f32 v163, v4, v147, -v163
  v_fma_f32 v164, v4, v148, -v164
  v_fma_f32 v165, v4, v149, -v165
  v_fma_f32 v166, v4, v150, -v166
  v_fma_f32 v167, v4, v151, -v167
  v_fma_f32 v168, v4, v152, -v168
  v_fma_f32 v169, v4, v153, -v169
  v_fma_f32 v170, v4, v154, -v170
  v_fma_f32 v171, v4, v155, -v171
  v_fma_f32 v172, v4, v156, -v172
  v_fma_f32 v173, v4, v157, -v173
  v_fma_f32 v174, v4, v158, -v174
  v_fma_f32 v175, v4, v159, -v175
  v_cvt_pk_bf16_f32 v200, v160, v161
  v_cvt_pk_bf16_f32 v201, v162, v163
  v_cvt_pk_bf16_f32 v202, v164, v165
  v_cvt_pk_bf16_f32 v203, v166, v167
  v_cvt_pk_bf16_f32 v204, v168, v169
  v_cvt_pk_bf16_f32 v205, v170, v171
  v_cvt_pk_bf16_f32 v206, v172, v173
  v_cvt_pk_bf16_f32 v207, v174, v175
  v_fma_f32 v144, v4, v160, -v144
  v_fma_f32 v145, v4, v161, -v145
  v_fma_f32 v146, v4, v162, -v146
  v_fma_f32 v147, v4, v163, -v147
  v_fma_f32 v148, v4, v164, -v148
  v_fma_f32 v149, v4, v165, -v149
  v_fma_f32 v150, v4, v166, -v150
  v_fma_f32 v151, v4, v167, -v151
  v_fma_f32 v152, v4, v168, -v152
  v_fma_f32 v153, v4, v169, -v153
  v_fma_f32 v154, v4, v170, -v154
  v_fma_f32 v155, v4, v171, -v155
  v_fma_f32 v156, v4, v172, -v156
  v_fma_f32 v157, v4, v173, -v157
  v_fma_f32 v158, v4, v174, -v158
  v_fma_f32 v159, v4, v175, -v159
  v_cvt_pk_bf16_f32 v208, v144, v145
  v_cvt_pk_bf16_f32 v209, v146, v147
  v_cvt_pk_bf16_f32 v210, v148, v149
  v_cvt_pk_bf16_f32 v211, v150, v151
  v_cvt_pk_bf16_f32 v212, v152, v153
  v_cvt_pk_bf16_f32 v213, v154, v155
  v_cvt_pk_bf16_f32 v214, v156, v157
  v_cvt_pk_bf16_f32 v215, v158, v159
  v_fma_f32 v160, v4, v144, -v160
  v_fma_f32 v161, v4, v145, -v161
  v_fma_f32 v162, v4, v146, -v162
  v_fma_f32 v163, v4, v147, -v163
  v_fma_f32 v164, v4, v148, -v164
  v_fma_f32 v165, v4, v149, -v165
  v_fma_f32 v166, v4, v150, -v166
  v_fma_f32 v167, v4, v151, -v167
  v_fma_f32 v168, v4, v152, -v168
  v_fma_f32 v169, v4, v153, -v169
  v_fma_f32 v170, v4, v154, -v170
  v_fma_f32 v171, v4, v155, -v171
  v_fma_f32 v172, v4, v156, -v172
  v_fma_f32 v173, v4, v157, -v173
  v_fma_f32 v174, v4, v158, -v174
  v_fma_f32 v175, v4, v159, -v175
  v_bfe_u32 v9, v0, 1, 3
  v_lshlrev_b32 v8, 1, v3
  v_xor_b32 v9, v9, v8
  v_lshlrev_b32 v9, 4, v9
  v_lshl_add_u32 v8, v1, 7, v9
  v_xor_b32 v9, 16, v8
  v_xor_b32 v14, 64, v8
  v_xor_b32 v15, 80, v8
  s_waitcnt vmcnt(6)
  ds_read_b128 v[16:19], v2 offset:0
  ds_read_b128 v[20:23], v6 offset:0
  s_waitcnt lgkmcnt(0)
  v_perm_b32 v24, v17, v16, s70
  v_perm_b32 v25, v19, v18, s70
  v_perm_b32 v26, v21, v20, s70
  v_perm_b32 v27, v23, v22, s70
  v_perm_b32 v28, v17, v16, s71
  v_perm_b32 v29, v19, v18, s71
  v_perm_b32 v30, v21, v20, s71
  v_perm_b32 v31, v23, v22, s71
  ds_write_b128 v2, v[24:27] offset:0
  ds_write_b128 v6, v[28:31] offset:0
  s_waitcnt lgkmcnt(0)
  s_barrier
  ds_read_b128 v[32:35], v8 offset:0
  ds_read_b128 v[36:39], v9 offset:0
  ds_read_b128 v[40:43], v8 offset:4096
  ds_read_b128 v[44:47], v9 offset:4096
  s_waitcnt lgkmcnt(0)
  ds_read_b128 v[48:51], v14 offset:0
  ds_read_b128 v[52:55], v15 offset:0
  ds_read_b128 v[56:59], v14 offset:4096
  ds_read_b128 v[60:63], v15 offset:4096
  v_mfma_f32_32x32x16_bf16 v[64:79], v[176:179], v[32:35], 0
  v_cvt_pk_bf16_f32 v216, v160, v161
  v_cvt_pk_bf16_f32 v217, v162, v163
  v_cvt_pk_bf16_f32 v218, v164, v165
  v_cvt_pk_bf16_f32 v219, v166, v167
  v_cvt_pk_bf16_f32 v220, v168, v169
  v_cvt_pk_bf16_f32 v221, v170, v171
  v_mfma_f32_32x32x16_bf16 v[96:111], v[180:183], v[36:39], 0
  v_cvt_pk_bf16_f32 v222, v172, v173
  v_cvt_pk_bf16_f32 v223, v174, v175
  v_fma_f32 v144, v4, v160, -v144
  v_fma_f32 v145, v4, v161, -v145
  v_fma_f32 v146, v4, v162, -v146
  v_fma_f32 v147, v4, v163, -v147
  v_mfma_f32_32x32x16_bf16 v[80:95], v[176:179], v[40:43], 0
  v_fma_f32 v148, v4, v164, -v148
  v_fma_f32 v149, v4, v165, -v149
  v_fma_f32 v150, v4, v166, -v150
  v_fma_f32 v151, v4, v167, -v151
  v_fma_f32 v152, v4, v168, -v152
  v_fma_f32 v153, v4, v169, -v153
  v_mfma_f32_32x32x16_bf16 v[112:127], v[180:183], v[44:47], 0
  v_fma_f32 v154, v4, v170, -v154
  v_fma_f32 v155, v4, v171, -v155
  v_fma_f32 v156, v4, v172, -v156
  v_fma_f32 v157, v4, v173, -v157
  v_fma_f32 v158, v4, v174, -v158
  v_fma_f32 v159, v4, v175, -v159
  s_waitcnt lgkmcnt(0)
  ds_read_b128 v[32:35], v8 offset:8192
  ds_read_b128 v[36:39], v9 offset:8192
  ds_read_b128 v[40:43], v8 offset:12288
  ds_read_b128 v[44:47], v9 offset:12288
  v_mfma_f32_32x32x16_bf16 v[64:79], v[184:187], v[48:51], v[64:79]
  v_cvt_pk_bf16_f32 v176, v144, v145
  v_cvt_pk_bf16_f32 v177, v146, v147
  v_cvt_pk_bf16_f32 v178, v148, v149
  v_cvt_pk_bf16_f32 v179, v150, v151
  v_cvt_pk_bf16_f32 v180, v152, v153
  v_cvt_pk_bf16_f32 v181, v154, v155
  v_mfma_f32_32x32x16_bf16 v[96:111], v[188:191], v[52:55], v[96:111]
  v_cvt_pk_bf16_f32 v182, v156, v157
  v_cvt_pk_bf16_f32 v183, v158, v159
  v_fma_f32 v160, v4, v144, -v160
  v_fma_f32 v161, v4, v145, -v161
  v_fma_f32 v162, v4, v146, -v162
  v_fma_f32 v163, v4, v147, -v163
  v_mfma_f32_32x32x16_bf16 v[80:95], v[184:187], v[56:59], v[80:95]
  v_fma_f32 v164, v4, v148, -v164
  v_fma_f32 v165, v4, v149, -v165
  v_fma_f32 v166, v4, v150, -v166
  v_fma_f32 v167, v4, v151, -v167
  v_fma_f32 v168, v4, v152, -v168
  v_fma_f32 v169, v4, v153, -v169
  v_mfma_f32_32x32x16_bf16 v[112:127], v[188:191], v[60:63], v[112:127]
  v_fma_f32 v170, v4, v154, -v170
  v_fma_f32 v171, v4, v155, -v171
  v_fma_f32 v172, v4, v156, -v172
  v_fma_f32 v173, v4, v157, -v173
  v_fma_f32 v174, v4, v158, -v174
  v_fma_f32 v175, v4, v159, -v175
  s_waitcnt lgkmcnt(0)
  ds_read_b128 v[48:51], v14 offset:8192
  ds_read_b128 v[52:55], v15 offset:8192
  ds_read_b128 v[56:59], v14 offset:12288
  ds_read_b128 v[60:63], v15 offset:12288
  v_mfma_f32_32x32x16_bf16 v[64:79], v[192:195], v[32:35], v[64:79]
  v_cvt_pk_bf16_f32 v184, v160, v161
  v_cvt_pk_bf16_f32 v185, v162, v163
  v_cvt_pk_bf16_f32 v186, v164, v165
  v_cvt_pk_bf16_f32 v187, v166, v167
  v_cvt_pk_bf16_f32 v188, v168, v169
  v_cvt_pk_bf16_f32 v189, v170, v171
  v_mfma_f32_32x32x16_bf16 v[96:111], v[196:199], v[36:39], v[96:111]
  v_cvt_pk_bf16_f32 v190, v172, v173
  v_cvt_pk_bf16_f32 v191, v174, v175
  v_fma_f32 v144, v4, v160, -v144
  v_fma_f32 v145, v4, v161, -v145
  v_fma_f32 v146, v4, v162, -v146
  v_fma_f32 v147, v4, v163, -v147
  v_mfma_f32_32x32x16_bf16 v[80:95], v[192:195], v[40:43], v[80:95]
  v_fma_f32 v148, v4, v164, -v148
  v_fma_f32 v149, v4, v165, -v149
  v_fma_f32 v150, v4, v166, -v150
  v_fma_f32 v151, v4, v167, -v151
  v_fma_f32 v152, v4, v168, -v152
  v_fma_f32 v153, v4, v169, -v153
  v_mfma_f32_32x32x16_bf16 v[112:127], v[196:199], v[44:47], v[112:127]
  v_fma_f32 v154, v4, v170, -v154
  v_fma_f32 v155, v4, v171, -v155
  v_fma_f32 v156, v4, v172, -v156
  v_fma_f32 v157, v4, v173, -v157
  v_fma_f32 v158, v4, v174, -v158
  v_fma_f32 v159, v4, v175, -v159
  s_waitcnt lgkmcnt(0)
  s_waitcnt vmcnt(1)
  ds_read_b128 v[16:19], v2 offset:16384
  ds_read_b128 v[20:23], v6 offset:16384
  ds_read_b128 v[128:131], v2 offset:32768
  ds_read_b128 v[132:135], v6 offset:32768
  s_mov_b32 exec_hi, 0
  ds_read_b128 v[240:243], v2 offset:49152
  ds_read_b128 v[244:247], v6 offset:49152
  s_mov_b64 exec, -1
  s_waitcnt lgkmcnt(4)
  v_perm_b32 v24, v17, v16, s70
  v_perm_b32 v25, v19, v18, s70
  v_perm_b32 v26, v21, v20, s70
  v_perm_b32 v27, v23, v22, s70
  v_perm_b32 v28, v17, v16, s71
  v_perm_b32 v29, v19, v18, s71
  v_perm_b32 v30, v21, v20, s71
  v_perm_b32 v31, v23, v22, s71
  ds_write_b128 v2, v[24:27] offset:16384
  ds_write_b128 v6, v[28:31] offset:16384
  s_waitcnt lgkmcnt(4)
  v_perm_b32 v136, v129, v128, s70
  v_perm_b32 v137, v131, v130, s70
  v_perm_b32 v138, v133, v132, s70
  v_perm_b32 v139, v135, v134, s70
  v_perm_b32 v140, v129, v128, s71
  v_perm_b32 v141, v131, v130, s71
  v_perm_b32 v142, v133, v132, s71
  v_perm_b32 v143, v135, v134, s71
  ds_write_b128 v2, v[136:139] offset:32768
  ds_write_b128 v6, v[140:143] offset:32768
  s_waitcnt lgkmcnt(4)
  v_perm_b32 v248, v241, v240, s70
  v_perm_b32 v249, v243, v242, s70
  v_perm_b32 v250, v245, v244, s70
  v_perm_b32 v251, v247, v246, s70
  v_perm_b32 v252, v241, v240, s71
  v_perm_b32 v253, v243, v242, s71
  v_perm_b32 v254, v245, v244, s71
  v_perm_b32 v255, v247, v246, s71
  s_mov_b32 exec_hi, 0
  ds_write_b128 v2, v[248:251] offset:49152
  ds_write_b128 v6, v[252:255] offset:49152
  s_mov_b64 exec, -1
  s_waitcnt lgkmcnt(0)
  s_barrier
  ds_read_b128 v[32:35], v8 offset:16384
  ds_read_b128 v[36:39], v9 offset:16384
  ds_read_b128 v[40:43], v8 offset:20480
  ds_read_b128 v[44:47], v9 offset:20480
  v_mfma_f32_32x32x16_bf16 v[64:79], v[200:203], v[48:51], v[64:79]
  v_cvt_pk_bf16_f32 v192, v144, v145
  v_cvt_pk_bf16_f32 v193, v146, v147
  v_cvt_pk_bf16_f32 v194, v148, v149
  v_cvt_pk_bf16_f32 v195, v150, v151
  v_cvt_pk_bf16_f32 v196, v152, v153
  v_cvt_pk_bf16_f32 v197, v154, v155
  v_mfma_f32_32x32x16_bf16 v[96:111], v[204:207], v[52:55], v[96:111]
  v_cvt_pk_bf16_f32 v198, v156, v157
  v_cvt_pk_bf16_f32 v199, v158, v159
  v_fma_f32 v160, v4, v144, -v160
  v_fma_f32 v161, v4, v145, -v161
  v_fma_f32 v162, v4, v146, -v162
  v_fma_f32 v163, v4, v147, -v163
  v_mfma_f32_32x32x16_bf16 v[80:95], v[200:203], v[56:59], v[80:95]
  v_fma_f32 v164, v4, v148, -v164
  v_fma_f32 v165, v4, v149, -v165
  v_fma_f32 v166, v4, v150, -v166
  v_fma_f32 v167, v4, v151, -v167
  v_fma_f32 v168, v4, v152, -v168
  v_fma_f32 v169, v4, v153, -v169
  v_mfma_f32_32x32x16_bf16 v[112:127], v[204:207], v[60:63], v[112:127]
  v_fma_f32 v170, v4, v154, -v170
  v_fma_f32 v171, v4, v155, -v171
  v_fma_f32 v172, v4, v156, -v172
  v_fma_f32 v173, v4, v157, -v173
  v_fma_f32 v174, v4, v158, -v174
  v_fma_f32 v175, v4, v159, -v175
  s_waitcnt lgkmcnt(0)
  ds_read_b128 v[48:51], v14 offset:16384
  ds_read_b128 v[52:55], v15 offset:16384
  ds_read_b128 v[56:59], v14 offset:20480
  ds_read_b128 v[60:63], v15 offset:20480
  v_mfma_f32_32x32x16_bf16 v[64:79], v[208:211], v[32:35], v[64:79]
  v_cvt_pk_bf16_f32 v200, v160, v161
  v_cvt_pk_bf16_f32 v201, v162, v163
  v_cvt_pk_bf16_f32 v202, v164, v165
  v_cvt_pk_bf16_f32 v203, v166, v167
  v_cvt_pk_bf16_f32 v204, v168, v169
  v_cvt_pk_bf16_f32 v205, v170, v171
  v_mfma_f32_32x32x16_bf16 v[96:111], v[212:215], v[36:39], v[96:111]
  v_cvt_pk_bf16_f32 v206, v172, v173
  v_cvt_pk_bf16_f32 v207, v174, v175
  v_fma_f32 v144, v4, v160, -v144
  v_fma_f32 v145, v4, v161, -v145
  v_fma_f32 v146, v4, v162, -v146
  v_fma_f32 v147, v4, v163, -v147
  v_mfma_f32_32x32x16_bf16 v[80:95], v[208:211], v[40:43], v[80:95]
  v_fma_f32 v148, v4, v164, -v148
  v_fma_f32 v149, v4, v165, -v149
  v_fma_f32 v150, v4, v166, -v150
  v_fma_f32 v151, v4, v167, -v151
  v_fma_f32 v152, v4, v168, -v152
  v_fma_f32 v153, v4, v169, -v153
  v_mfma_f32_32x32x16_bf16 v[112:127], v[212:215], v[44:47], v[112:127]
  v_fma_f32 v154, v4, v170, -v154
  v_fma_f32 v155, v4, v171, -v155
  v_fma_f32 v156, v4, v172, -v156
  v_fma_f32 v157, v4, v173, -v157
  v_fma_f32 v158, v4, v174, -v158
  v_fma_f32 v159, v4, v175, -v159
  s_waitcnt lgkmcnt(0)
  ds_read_b128 v[32:35], v8 offset:24576
  ds_read_b128 v[36:39], v9 offset:24576
  ds_read_b128 v[40:43], v8 offset:28672
  ds_read_b128 v[44:47], v9 offset:28672
  v_mfma_f32_32x32x16_bf16 v[64:79], v[216:219], v[48:51], v[64:79]
  v_cvt_pk_bf16_f32 v208, v144, v145
  v_cvt_pk_bf16_f32 v209, v146, v147
  v_cvt_pk_bf16_f32 v210, v148, v149
  v_cvt_pk_bf16_f32 v211, v150, v151
  v_cvt_pk_bf16_f32 v212, v152, v153
  v_cvt_pk_bf16_f32 v213, v154, v155
  v_mfma_f32_32x32x16_bf16 v[96:111], v[220:223], v[52:55], v[96:111]
  v_cvt_pk_bf16_f32 v214, v156, v157
  v_cvt_pk_bf16_f32 v215, v158, v159
  v_fma_f32 v160, v4, v144, -v160
  v_fma_f32 v161, v4, v145, -v161
  v_fma_f32 v162, v4, v146, -v162
  v_fma_f32 v163, v4, v147, -v163
  v_mfma_f32_32x32x16_bf16 v[80:95], v[216:219], v[56:59], v[80:95]
  v_fma_f32 v164, v4, v148, -v164
  v_fma_f32 v165, v4, v149, -v165
  v_fma_f32 v166, v4, v150, -v166
  v_fma_f32 v167, v4, v151, -v167
  v_fma_f32 v168, v4, v152, -v168
  v_fma_f32 v169, v4, v153, -v169
  v_mfma_f32_32x32x16_bf16 v[112:127], v[220:223], v[60:63], v[112:127]
  v_fma_f32 v170, v4, v154, -v170
  v_fma_f32 v171, v4, v155, -v171
  v_fma_f32 v172, v4, v156, -v172
  v_fma_f32 v173, v4, v157, -v173
  v_fma_f32 v174, v4, v158, -v174
  v_fma_f32 v175, v4, v159, -v175
  s_waitcnt lgkmcnt(0)
  ds_read_b128 v[48:51], v14 offset:24576
  ds_read_b128 v[52:55], v15 offset:24576
  ds_read_b128 v[56:59], v14 offset:28672
  ds_read_b128 v[60:63], v15 offset:28672
  v_mfma_f32_32x32x16_bf16 v[64:79], v[176:179], v[32:35], v[64:79]
  v_cvt_pk_bf16_f32 v216, v160, v161
  v_cvt_pk_bf16_f32 v217, v162, v163
  v_cvt_pk_bf16_f32 v218, v164, v165
  v_cvt_pk_bf16_f32 v219, v166, v167
  v_cvt_pk_bf16_f32 v220, v168, v169
  v_cvt_pk_bf16_f32 v221, v170, v171
  v_mfma_f32_32x32x16_bf16 v[96:111], v[180:183], v[36:39], v[96:111]
  v_cvt_pk_bf16_f32 v222, v172, v173
  v_cvt_pk_bf16_f32 v223, v174, v175
  v_fma_f32 v144, v4, v160, -v144
  v_fma_f32 v145, v4, v161, -v145
  v_fma_f32 v146, v4, v162, -v146
  v_fma_f32 v147, v4, v163, -v147
  v_mfma_f32_32x32x16_bf16 v[80:95], v[176:179], v[40:43], v[80:95]
  v_fma_f32 v148, v4, v164, -v148
  v_fma_f32 v149, v4, v165, -v149
  v_fma_f32 v150, v4, v166, -v150
  v_fma_f32 v151, v4, v167, -v151
  v_fma_f32 v152, v4, v168, -v152
  v_fma_f32 v153, v4, v169, -v153
  v_mfma_f32_32x32x16_bf16 v[112:127], v[180:183], v[44:47], v[112:127]
  v_fma_f32 v154, v4, v170, -v154
  v_fma_f32 v155, v4, v171, -v155
  v_fma_f32 v156, v4, v172, -v156
  v_fma_f32 v157, v4, v173, -v157
  v_fma_f32 v158, v4, v174, -v158
  v_fma_f32 v159, v4, v175, -v159
  s_waitcnt lgkmcnt(0)
  ds_read_b128 v[32:35], v8 offset:32768
  ds_read_b128 v[36:39], v9 offset:32768
  ds_read_b128 v[40:43], v8 offset:36864
  ds_read_b128 v[44:47], v9 offset:36864
  v_mfma_f32_32x32x16_bf16 v[64:79], v[184:187], v[48:51], v[64:79]
  v_cvt_pk_bf16_f32 v176, v144, v145
  v_cvt_pk_bf16_f32 v177, v146, v147
  v_cvt_pk_bf16_f32 v178, v148, v149
  v_cvt_pk_bf16_f32 v179, v150, v151
  v_cvt_pk_bf16_f32 v180, v152, v153
  v_cvt_pk_bf16_f32 v181, v154, v155
  v_mfma_f32_32x32x16_bf16 v[96:111], v[188:191], v[52:55], v[96:111]
  v_cvt_pk_bf16_f32 v182, v156, v157
  v_cvt_pk_bf16_f32 v183, v158, v159
  v_fma_f32 v160, v4, v144, -v160
  v_fma_f32 v161, v4, v145, -v161
  v_fma_f32 v162, v4, v146, -v162
  v_fma_f32 v163, v4, v147, -v163
  v_mfma_f32_32x32x16_bf16 v[80:95], v[184:187], v[56:59], v[80:95]
  v_fma_f32 v164, v4, v148, -v164
  v_fma_f32 v165, v4, v149, -v165
  v_fma_f32 v166, v4, v150, -v166
  v_fma_f32 v167, v4, v151, -v167
  v_fma_f32 v168, v4, v152, -v168
  v_fma_f32 v169, v4, v153, -v169
  v_mfma_f32_32x32x16_bf16 v[112:127], v[188:191], v[60:63], v[112:127]
  v_fma_f32 v170, v4, v154, -v170
  v_fma_f32 v171, v4, v155, -v171
  v_fma_f32 v172, v4, v156, -v172
  v_fma_f32 v173, v4, v157, -v173
  v_fma_f32 v174, v4, v158, -v174
  v_fma_f32 v175, v4, v159, -v175
  s_waitcnt lgkmcnt(0)
  ds_read_b128 v[48:51], v14 offset:32768
  ds_read_b128 v[52:55], v15 offset:32768
  ds_read_b128 v[56:59], v14 offset:36864
  ds_read_b128 v[60:63], v15 offset:36864
  v_mfma_f32_32x32x16_bf16 v[64:79], v[192:195], v[32:35], v[64:79]
  v_cvt_pk_bf16_f32 v184, v160, v161
  v_cvt_pk_bf16_f32 v185, v162, v163
  v_mfma_f32_32x32x16_bf16 v[96:111], v[196:199], v[36:39], v[96:111]
  v_cvt_pk_bf16_f32 v186, v164, v165
  v_cvt_pk_bf16_f32 v187, v166, v167
  v_mfma_f32_32x32x16_bf16 v[80:95], v[192:195], v[40:43], v[80:95]
  v_cvt_pk_bf16_f32 v188, v168, v169
  v_cvt_pk_bf16_f32 v189, v170, v171
  v_mfma_f32_32x32x16_bf16 v[112:127], v[196:199], v[44:47], v[112:127]
  v_cvt_pk_bf16_f32 v190, v172, v173
  v_cvt_pk_bf16_f32 v191, v174, v175
  s_waitcnt lgkmcnt(0)
  ds_read_b128 v[32:35], v8 offset:40960
  ds_read_b128 v[36:39], v9 offset:40960
  ds_read_b128 v[40:43], v8 offset:45056
  ds_read_b128 v[44:47], v9 offset:45056
  v_mfma_f32_32x32x16_bf16 v[64:79], v[200:203], v[48:51], v[64:79]
  v_mfma_f32_32x32x16_bf16 v[96:111], v[204:207], v[52:55], v[96:111]
  v_mfma_f32_32x32x16_bf16 v[80:95], v[200:203], v[56:59], v[80:95]
  v_mfma_f32_32x32x16_bf16 v[112:127], v[204:207], v[60:63], v[112:127]
  s_waitcnt lgkmcnt(0)
  ds_read_b128 v[48:51], v14 offset:40960
  ds_read_b128 v[52:55], v15 offset:40960
  ds_read_b128 v[56:59], v14 offset:45056
  ds_read_b128 v[60:63], v15 offset:45056
  v_mfma_f32_32x32x16_bf16 v[64:79], v[208:211], v[32:35], v[64:79]
  v_mfma_f32_32x32x16_bf16 v[96:111], v[212:215], v[36:39], v[96:111]
  v_mfma_f32_32x32x16_bf16 v[80:95], v[208:211], v[40:43], v[80:95]
  v_mfma_f32_32x32x16_bf16 v[112:127], v[212:215], v[44:47], v[112:127]
  s_waitcnt lgkmcnt(0)
  ds_read_b128 v[32:35], v8 offset:49152
  ds_read_b128 v[36:39], v9 offset:49152
  ds_read_b128 v[40:43], v8 offset:53248
  ds_read_b128 v[44:47], v9 offset:53248
  v_mfma_f32_32x32x16_bf16 v[64:79], v[216:219], v[48:51], v[64:79]
  v_mfma_f32_32x32x16_bf16 v[96:111], v[220:223], v[52:55], v[96:111]
  v_mfma_f32_32x32x16_bf16 v[80:95], v[216:219], v[56:59], v[80:95]
  v_mfma_f32_32x32x16_bf16 v[112:127], v[220:223], v[60:63], v[112:127]
  s_waitcnt lgkmcnt(0)
  ds_read_b128 v[48:51], v14 offset:49152
  ds_read_b128 v[52:55], v15 offset:49152
  ds_read_b128 v[56:59], v14 offset:53248
  ds_read_b128 v[60:63], v15 offset:53248
  v_mfma_f32_32x32x16_bf16 v[64:79], v[176:179], v[32:35], v[64:79]
  v_mfma_f32_32x32x16_bf16 v[96:111], v[180:183], v[36:39], v[96:111]
  v_mfma_f32_32x32x16_bf16 v[80:95], v[176:179], v[40:43], v[80:95]
  v_mfma_f32_32x32x16_bf16 v[112:127], v[180:183], v[44:47], v[112:127]
  s_waitcnt lgkmcnt(0)
  v_mfma_f32_32x32x16_bf16 v[64:79], v[184:187], v[48:51], v[64:79]
  v_mfma_f32_32x32x16_bf16 v[96:111], v[188:191], v[52:55], v[96:111]
  v_mfma_f32_32x32x16_bf16 v[80:95], v[184:187], v[56:59], v[80:95]
  v_mfma_f32_32x32x16_bf16 v[112:127], v[188:191], v[60:63], v[112:127]
  v_lshlrev_b32 v8, 3, v1
  v_add_u32 v8, 123392, v8
  v_mov_b32 v9, 155776
  s_mov_b32 s77, 400000
df_sp:
  ds_read_b32 v20, v9
  ds_read_b64 v[16:17], v8
  ds_read_b64 v[18:19], v8 offset:256
  s_waitcnt lgkmcnt(0)
  v_readfirstlane_b32 s67, v20
  s_sub_u32 s77, s77, 1
  s_cbranch_scc1 df_spok
  s_cmp_eq_u32 s67, 0
  s_cbranch_scc1 df_sp
df_spok:
  v_mul_f32 v96, v96, v16
  v_mul_f32 v97, v97, v16
  v_fma_f32 v20, v64, v16, v96
  v_fma_f32 v21, v65, v16, v97
  v_fma_f32 v22, v64, v16, -v96
  v_fma_f32 v23, -v65, v16, v97
  v_mul_f32 v24, v65, v16
  v_sub_f32 v25, v20, v17
  v_cndmask_b32 v20, v20, v25, s[80:81]
  v_cndmask_b32 v21, v21, v22, s[80:81]
  v_cndmask_b32 v22, v22, v24, s[80:81]
  v_cndmask_b32 v23, v23, v97, s[80:81]
  v_cvt_pk_bf16_f32 v144, v20, v21
  v_cvt_pk_bf16_f32 v148, v22, v23
  v_mul_f32 v112, v112, v18
  v_mul_f32 v113, v113, v18
  v_fma_f32 v26, v80, v18, v112
  v_fma_f32 v27, v81, v18, v113
  v_fma_f32 v28, v80, v18, -v112
  v_fma_f32 v29, -v81, v18, v113
  v_mul_f32 v30, v81, v18
  v_sub_f32 v31, v26, v19
  v_cndmask_b32 v26, v26, v31, s[80:81]
  v_cndmask_b32 v27, v27, v28, s[80:81]
  v_cndmask_b32 v28, v28, v30, s[80:81]
  v_cndmask_b32 v29, v29, v113, s[80:81]
  v_cvt_pk_bf16_f32 v146, v26, v27
  v_cvt_pk_bf16_f32 v150, v28, v29
  v_mul_f32 v98, v98, v16
  v_mul_f32 v99, v99, v16
  v_fma_f32 v20, v66, v16, v98
  v_fma_f32 v21, v67, v16, v99
  v_fma_f32 v22, v66, v16, -v98
  v_fma_f32 v23, -v67, v16, v99
  v_cvt_pk_bf16_f32 v145, v20, v21
  v_cvt_pk_bf16_f32 v149, v22, v23
  v_mul_f32 v114, v114, v18
  v_mul_f32 v115, v115, v18
  v_fma_f32 v26, v82, v18, v114
  v_fma_f32 v27, v83, v18, v115
  v_fma_f32 v28, v82, v18, -v114
  v_fma_f32 v29, -v83, v18, v115
  v_cvt_pk_bf16_f32 v147, v26, v27
  v_cvt_pk_bf16_f32 v151, v28, v29
  v_permlane16_swap_b32 v144, v145
  v_permlane16_swap_b32 v146, v147
  v_permlane16_swap_b32 v148, v149
  v_permlane16_swap_b32 v150, v151
  s_add_u32 s67, s84, 0
  buffer_store_dwordx4 v[144:147], v10, s[44:47], s67 offen sc0 sc1
  buffer_store_dwordx4 v[148:151], v13, s[44:47], s83 offen sc0 sc1
  v_mul_f32 v100, v100, v16
  v_mul_f32 v101, v101, v16
  v_fma_f32 v20, v68, v16, v100
  v_fma_f32 v21, v69, v16, v101
  v_fma_f32 v22, v68, v16, -v100
  v_fma_f32 v23, -v69, v16, v101
  v_cvt_pk_bf16_f32 v152, v20, v21
  v_cvt_pk_bf16_f32 v156, v22, v23
  v_mul_f32 v116, v116, v18
  v_mul_f32 v117, v117, v18
  v_fma_f32 v26, v84, v18, v116
  v_fma_f32 v27, v85, v18, v117
  v_fma_f32 v28, v84, v18, -v116
  v_fma_f32 v29, -v85, v18, v117
  v_cvt_pk_bf16_f32 v154, v26, v27
  v_cvt_pk_bf16_f32 v158, v28, v29
  v_mul_f32 v102, v102, v16
  v_mul_f32 v103, v103, v16
  v_fma_f32 v20, v70, v16, v102
  v_fma_f32 v21, v71, v16, v103
  v_fma_f32 v22, v70, v16, -v102
  v_fma_f32 v23, -v71, v16, v103
  v_cvt_pk_bf16_f32 v153, v20, v21
  v_cvt_pk_bf16_f32 v157, v22, v23
  v_mul_f32 v118, v118, v18
  v_mul_f32 v119, v119, v18
  v_fma_f32 v26, v86, v18, v118
  v_fma_f32 v27, v87, v18, v119
  v_fma_f32 v28, v86, v18, -v118
  v_fma_f32 v29, -v87, v18, v119
  v_cvt_pk_bf16_f32 v155, v26, v27
  v_cvt_pk_bf16_f32 v159, v28, v29
  v_permlane16_swap_b32 v152, v153
  v_permlane16_swap_b32 v154, v155
  v_permlane16_swap_b32 v156, v157
  v_permlane16_swap_b32 v158, v159
  s_add_u32 s67, s84, 34816
  buffer_store_dwordx4 v[152:155], v10, s[44:47], s67 offen sc0 sc1
  s_sub_u32 s67, s86, 34816
  buffer_store_dwordx4 v[156:159], v11, s[44:47], s67 offen sc0 sc1
  v_mul_f32 v104, v104, v16
  v_mul_f32 v105, v105, v16
  v_fma_f32 v20, v72, v16, v104
  v_fma_f32 v21, v73, v16, v105
  v_fma_f32 v22, v72, v16, -v104
  v_fma_f32 v23, -v73, v16, v105
  v_cvt_pk_bf16_f32 v160, v20, v21
  v_cvt_pk_bf16_f32 v164, v22, v23
  v_mul_f32 v120, v120, v18
  v_mul_f32 v121, v121, v18
  v_fma_f32 v26, v88, v18, v120
  v_fma_f32 v27, v89, v18, v121
  v_fma_f32 v28, v88, v18, -v120
  v_fma_f32 v29, -v89, v18, v121
  v_cvt_pk_bf16_f32 v162, v26, v27
  v_cvt_pk_bf16_f32 v166, v28, v29
  v_mul_f32 v106, v106, v16
  v_mul_f32 v107, v107, v16
  v_fma_f32 v20, v74, v16, v106
  v_fma_f32 v21, v75, v16, v107
  v_fma_f32 v22, v74, v16, -v106
  v_fma_f32 v23, -v75, v16, v107
  v_cvt_pk_bf16_f32 v161, v20, v21
  v_cvt_pk_bf16_f32 v165, v22, v23
  v_mul_f32 v122, v122, v18
  v_mul_f32 v123, v123, v18
  v_fma_f32 v26, v90, v18, v122
  v_fma_f32 v27, v91, v18, v123
  v_fma_f32 v28, v90, v18, -v122
  v_fma_f32 v29, -v91, v18, v123
  v_cvt_pk_bf16_f32 v163, v26, v27
  v_cvt_pk_bf16_f32 v167, v28, v29
  v_permlane16_swap_b32 v160, v161
  v_permlane16_swap_b32 v162, v163
  v_permlane16_swap_b32 v164, v165
  v_permlane16_swap_b32 v166, v167
  s_add_u32 s67, s84, 69632
  buffer_store_dwordx4 v[160:163], v10, s[44:47], s67 offen sc0 sc1
  s_sub_u32 s67, s86, 69632
  buffer_store_dwordx4 v[164:167], v11, s[44:47], s67 offen sc0 sc1
  v_mul_f32 v108, v108, v16
  v_mul_f32 v109, v109, v16
  v_fma_f32 v20, v76, v16, v108
  v_fma_f32 v21, v77, v16, v109
  v_fma_f32 v22, v76, v16, -v108
  v_fma_f32 v23, -v77, v16, v109
  v_cvt_pk_bf16_f32 v168, v20, v21
  v_cvt_pk_bf16_f32 v172, v22, v23
  v_mul_f32 v124, v124, v18
  v_mul_f32 v125, v125, v18
  v_fma_f32 v26, v92, v18, v124
  v_fma_f32 v27, v93, v18, v125
  v_fma_f32 v28, v92, v18, -v124
  v_fma_f32 v29, -v93, v18, v125
  v_cvt_pk_bf16_f32 v170, v26, v27
  v_cvt_pk_bf16_f32 v174, v28, v29
  v_mul_f32 v110, v110, v16
  v_mul_f32 v111, v111, v16
  v_fma_f32 v20, v78, v16, v110
  v_fma_f32 v21, v79, v16, v111
  v_fma_f32 v22, v78, v16, -v110
  v_fma_f32 v23, -v79, v16, v111
  v_cvt_pk_bf16_f32 v169, v20, v21
  v_cvt_pk_bf16_f32 v173, v22, v23
  v_mul_f32 v126, v126, v18
  v_mul_f32 v127, v127, v18
  v_fma_f32 v26, v94, v18, v126
  v_fma_f32 v27, v95, v18, v127
  v_fma_f32 v28, v94, v18, -v126
  v_fma_f32 v29, -v95, v18, v127
  v_cvt_pk_bf16_f32 v171, v26, v27
  v_cvt_pk_bf16_f32 v175, v28, v29
  v_permlane16_swap_b32 v168, v169
  v_permlane16_swap_b32 v170, v171
  v_permlane16_swap_b32 v172, v173
  v_permlane16_swap_b32 v174, v175
  s_add_u32 s67, s84, 104448
  buffer_store_dwordx4 v[168:171], v10, s[44:47], s67 offen sc0 sc1
  s_sub_u32 s67, s86, 104448
  buffer_store_dwordx4 v[172:175], v11, s[44:47], s67 offen sc0 sc1
  s_waitcnt vmcnt(0)
  s_barrier
dft_tail:
  s_cmp_lg_u32 s2, 0
  s_cbranch_scc1 dft_end
  s_cmp_lt_u32 s3, 4
  s_cbranch_scc1 dft_end
  v_and_b32 v22, 15, v0
  v_lshrrev_b32 v21, 4, v0
  s_lshl_b32 s67, s64, 4
  v_add_u32 v20, s67, v22
  v_cvt_f32_u32 v20, v20
  v_lshlrev_b32 v21, 2, v21
  v_cvt_f32_u32 v21, v21
  v_cvt_f32_u32 v22, v22
  v_mul_f32 v23, 0x3c800000, v20
  v_mul_f32 v24, v23, v21
  v_mul_f32 v25, 0x41400000, v23
  v_cos_f32 v26, v24
  v_sin_f32 v27, v24
  v_add_f32 v24, v24, v23
  v_cvt_pk_bf16_f32 v128, v26, v27
  v_cvt_pk_bf16_f32 v144, -v27, v26
  v_cos_f32 v26, v24
  v_sin_f32 v27, v24
  v_add_f32 v24, v24, v23
  v_cvt_pk_bf16_f32 v129, v26, v27
  v_cvt_pk_bf16_f32 v145, -v27, v26
  v_cos_f32 v26, v24
  v_sin_f32 v27, v24
  v_add_f32 v24, v24, v23
  v_cvt_pk_bf16_f32 v130, v26, v27
  v_cvt_pk_bf16_f32 v146, -v27, v26
  v_cos_f32 v26, v24
  v_sin_f32 v27, v24
  v_add_f32 v24, v24, v23
  v_cvt_pk_bf16_f32 v131, v26, v27
  v_cvt_pk_bf16_f32 v147, -v27, v26
  v_add_f32 v24, v24, v25
  v_cos_f32 v26, v24
  v_sin_f32 v27, v24
  v_add_f32 v24, v24, v23
  v_cvt_pk_bf16_f32 v132, v26, v27
  v_cvt_pk_bf16_f32 v148, -v27, v26
  v_cos_f32 v26, v24
  v_sin_f32 v27, v24
  v_add_f32 v24, v24, v23
  v_cvt_pk_bf16_f32 v133, v26, v27
  v_cvt_pk_bf16_f32 v149, -v27, v26
  v_cos_f32 v26, v24
  v_sin_f32 v27, v24
  v_add_f32 v24, v24, v23
  v_cvt_pk_bf16_f32 v134, v26, v27
  v_cvt_pk_bf16_f32 v150, -v27, v26
  v_cos_f32 v26, v24
  v_sin_f32 v27, v24
  v_add_f32 v24, v24, v23
  v_cvt_pk_bf16_f32 v135, v26, v27
  v_cvt_pk_bf16_f32 v151, -v27, v26
  v_add_f32 v24, v24, v25
  v_cos_f32 v26, v24
  v_sin_f32 v27, v24
  v_add_f32 v24, v24, v23
  v_cvt_pk_bf16_f32 v136, v26, v27
  v_cvt_pk_bf16_f32 v152, -v27, v26
  v_cos_f32 v26, v24
  v_sin_f32 v27, v24
  v_add_f32 v24, v24, v23
  v_cvt_pk_bf16_f32 v137, v26, v27
  v_cvt_pk_bf16_f32 v153, -v27, v26
  v_cos_f32 v26, v24
  v_sin_f32 v27, v24
  v_add_f32 v24, v24, v23
  v_cvt_pk_bf16_f32 v138, v26, v27
  v_cvt_pk_bf16_f32 v154, -v27, v26
  v_cos_f32 v26, v24
  v_sin_f32 v27, v24
  v_add_f32 v24, v24, v23
  v_cvt_pk_bf16_f32 v139, v26, v27
  v_cvt_pk_bf16_f32 v155, -v27, v26
  v_add_f32 v24, v24, v25
  v_cos_f32 v26, v24
  v_sin_f32 v27, v24
  v_add_f32 v24, v24, v23
  v_cvt_pk_bf16_f32 v140, v26, v27
  v_cvt_pk_bf16_f32 v156, -v27, v26
  v_cos_f32 v26, v24
  v_sin_f32 v27, v24
  v_add_f32 v24, v24, v23
  v_cvt_pk_bf16_f32 v141, v26, v27
  v_cvt_pk_bf16_f32 v157, -v27, v26
  v_cos_f32 v26, v24
  v_sin_f32 v27, v24
  v_add_f32 v24, v24, v23
  v_cvt_pk_bf16_f32 v142, v26, v27
  v_cvt_pk_bf16_f32 v158, -v27, v26
  v_cos_f32 v26, v24
  v_sin_f32 v27, v24
  v_add_f32 v24, v24, v23
  v_cvt_pk_bf16_f32 v143, v26, v27
  v_cvt_pk_bf16_f32 v159, -v27, v26
  v_add_f32 v23, 0x00000000, v22
  v_mul_f32 v23, 0x3d000000, v23
  v_mul_f32 v24, v23, v21
  v_mul_f32 v25, 0x41400000, v23
  v_cos_f32 v26, v24
  v_sin_f32 v27, v24
  v_add_f32 v24, v24, v23
  v_cvt_pk_bf16_f32 v160, v26, v27
  v_cvt_pk_bf16_f32 v176, -v27, v26
  v_cos_f32 v26, v24
  v_sin_f32 v27, v24
  v_add_f32 v24, v24, v23
  v_cvt_pk_bf16_f32 v161, v26, v27
  v_cvt_pk_bf16_f32 v177, -v27, v26
  v_cos_f32 v26, v24
  v_sin_f32 v27, v24
  v_add_f32 v24, v24, v23
  v_cvt_pk_bf16_f32 v162, v26, v27
  v_cvt_pk_bf16_f32 v178, -v27, v26
  v_cos_f32 v26, v24
  v_sin_f32 v27, v24
  v_add_f32 v24, v24, v23
  v_cvt_pk_bf16_f32 v163, v26, v27
  v_cvt_pk_bf16_f32 v179, -v27, v26
  v_add_f32 v24, v24, v25
  v_cos_f32 v26, v24
  v_sin_f32 v27, v24
  v_add_f32 v24, v24, v23
  v_cvt_pk_bf16_f32 v164, v26, v27
  v_cvt_pk_bf16_f32 v180, -v27, v26
  v_cos_f32 v26, v24
  v_sin_f32 v27, v24
  v_add_f32 v24, v24, v23
  v_cvt_pk_bf16_f32 v165, v26, v27
  v_cvt_pk_bf16_f32 v181, -v27, v26
  v_cos_f32 v26, v24
  v_sin_f32 v27, v24
  v_add_f32 v24, v24, v23
  v_cvt_pk_bf16_f32 v166, v26, v27
  v_cvt_pk_bf16_f32 v182, -v27, v26
  v_cos_f32 v26, v24
  v_sin_f32 v27, v24
  v_add_f32 v24, v24, v23
  v_cvt_pk_bf16_f32 v167, v26, v27
  v_cvt_pk_bf16_f32 v183, -v27, v26
  v_add_f32 v23, 0x41800000, v22
  v_mul_f32 v23, 0x3d000000, v23
  v_mul_f32 v24, v23, v21
  v_mul_f32 v25, 0x41400000, v23
  v_cos_f32 v26, v24
  v_sin_f32 v27, v24
  v_add_f32 v24, v24, v23
  v_cvt_pk_bf16_f32 v168, v26, v27
  v_cvt_pk_bf16_f32 v184, -v27, v26
  v_cos_f32 v26, v24
  v_sin_f32 v27, v24
  v_add_f32 v24, v24, v23
  v_cvt_pk_bf16_f32 v169, v26, v27
  v_cvt_pk_bf16_f32 v185, -v27, v26
  v_cos_f32 v26, v24
  v_sin_f32 v27, v24
  v_add_f32 v24, v24, v23
  v_cvt_pk_bf16_f32 v170, v26, v27
  v_cvt_pk_bf16_f32 v186, -v27, v26
  v_cos_f32 v26, v24
  v_sin_f32 v27, v24
  v_add_f32 v24, v24, v23
  v_cvt_pk_bf16_f32 v171, v26, v27
  v_cvt_pk_bf16_f32 v187, -v27, v26
  v_add_f32 v24, v24, v25
  v_cos_f32 v26, v24
  v_sin_f32 v27, v24
  v_add_f32 v24, v24, v23
  v_cvt_pk_bf16_f32 v172, v26, v27
  v_cvt_pk_bf16_f32 v188, -v27, v26
  v_cos_f32 v26, v24
  v_sin_f32 v27, v24
  v_add_f32 v24, v24, v23
  v_cvt_pk_bf16_f32 v173, v26, v27
  v_cvt_pk_bf16_f32 v189, -v27, v26
  v_cos_f32 v26, v24
  v_sin_f32 v27, v24
  v_add_f32 v24, v24, v23
  v_cvt_pk_bf16_f32 v174, v26, v27
  v_cvt_pk_bf16_f32 v190, -v27, v26
  v_cos_f32 v26, v24
  v_sin_f32 v27, v24
  v_add_f32 v24, v24, v23
  v_cvt_pk_bf16_f32 v175, v26, v27
  v_cvt_pk_bf16_f32 v191, -v27, v26
  v_mul_f32 v23, 0x3a000000, v20
  v_mul_f32 v24, v23, v21
  v_mul_f32 v25, 0x41400000, v23
  v_cos_f32 v192, v24
  v_sin_f32 v193, v24
  v_add_f32 v24, v24, v23
  v_cos_f32 v194, v24
  v_sin_f32 v195, v24
  v_add_f32 v24, v24, v23
  v_cos_f32 v196, v24
  v_sin_f32 v197, v24
  v_add_f32 v24, v24, v23
  v_cos_f32 v198, v24
  v_sin_f32 v199, v24
  v_add_f32 v24, v24, v23
  v_add_f32 v24, v24, v25
  v_cos_f32 v200, v24
  v_sin_f32 v201, v24
  v_add_f32 v24, v24, v23
  v_cos_f32 v202, v24
  v_sin_f32 v203, v24
  v_add_f32 v24, v24, v23
  v_cos_f32 v204, v24
  v_sin_f32 v205, v24
  v_add_f32 v24, v24, v23
  v_cos_f32 v206, v24
  v_sin_f32 v207, v24
  v_add_f32 v24, v24, v23
  v_cvt_f32_u32 v28, s67
  v_add_f32 v28, v28, v21
  v_add_f32 v23, 0x00000000, v22
  v_mul_f32 v23, 0x3a000000, v23
  v_mul_f32 v24, v23, v28
  v_cos_f32 v208, v24
  v_sin_f32 v209, v24
  v_add_f32 v24, v24, v23
  v_cos_f32 v210, v24
  v_sin_f32 v211, v24
  v_add_f32 v24, v24, v23
  v_cos_f32 v212, v24
  v_sin_f32 v213, v24
  v_add_f32 v24, v24, v23
  v_cos_f32 v214, v24
  v_sin_f32 v215, v24
  v_add_f32 v24, v24, v23
  v_add_f32 v23, 0x41800000, v22
  v_mul_f32 v23, 0x3a000000, v23
  v_mul_f32 v24, v23, v28
  v_cos_f32 v216, v24
  v_sin_f32 v217, v24
  v_add_f32 v24, v24, v23
  v_cos_f32 v218, v24
  v_sin_f32 v219, v24
  v_add_f32 v24, v24, v23
  v_cos_f32 v220, v24
  v_sin_f32 v221, v24
  v_add_f32 v24, v24, v23
  v_cos_f32 v222, v24
  v_sin_f32 v223, v24
  v_add_f32 v24, v24, v23
  v_mul_f32 v208, 0x36124925, v208
  v_mul_f32 v209, 0x36124925, v209
  v_mul_f32 v210, 0x36124925, v210
  v_mul_f32 v211, 0x36124925, v211
  v_mul_f32 v212, 0x36124925, v212
  v_mul_f32 v213, 0x36124925, v213
  v_mul_f32 v214, 0x36124925, v214
  v_mul_f32 v215, 0x36124925, v215
  v_mul_f32 v216, 0x36124925, v216
  v_mul_f32 v217, 0x36124925, v217
  v_mul_f32 v218, 0x36124925, v218
  v_mul_f32 v219, 0x36124925, v219
  v_mul_f32 v220, 0x36124925, v220
  v_mul_f32 v221, 0x36124925, v221
  v_mul_f32 v222, 0x36124925, v222
  v_mul_f32 v223, 0x36124925, v223
  s_mov_b32 s62, 0
  s_mov_b32 s63, 224
  s_mov_b32 s76, 1
  v_mov_b32 v29, 0
  v_mov_b32 v17, 0
  s_add_u32 s44, s22, 7405568
  s_addc_u32 s45, s23, 0
  s_mov_b32 s46, 1949696
  s_mov_b32 s47, 0x00020000
  s_add_u32 s48, s22, 9355264
  s_addc_u32 s49, s23, 0
  s_mov_b32 s50, 1909248
  s_mov_b32 s51, 0x00020000
  s_add_u32 s40, s22, 13181696
  s_addc_u32 s41, s23, 0
  s_mov_b32 s42, 65536
  s_mov_b32 s43, 0x00020000
  v_and_b32 v1, 15, v0
  v_lshrrev_b32 v2, 4, v0
  v_lshlrev_b32 v3, 4, v0
  s_mul_i32 s69, s62, 8704
  s_add_u32 s70, s69, 4096
  v_and_b32 v5, 1, v0
  v_lshlrev_b32 v5, 7, v5
  v_lshrrev_b32 v6, 1, v1
  v_lshl_add_u32 v5, v6, 4, v5
  v_lshl_add_u32 v5, v2, 10, v5
  v_lshlrev_b32 v6, 4, v1
  v_lshl_add_u32 v6, v2, 9, v6
  s_mul_i32 s71, s63, 8448
  s_lshl_b32 s72, s64, 8
  s_add_u32 s71, s71, s72
  s_add_u32 s71, s71, 8448
  s_add_u32 s72, s71, 4096
  s_and_b32 s65, s63, 63
  s_lshl_b32 s65, s65, 7
  v_mov_b32 v18, s65
  s_and_b32 s65, s63, 3
  s_lshl_b32 s65, s65, 7
  s_add_u32 s65, s65, 57344
  s_lshr_b32 s68, s63, 5
  s_lshl_b32 s68, s68, 9
  s_add_u32 s68, s68, s65
  v_writelane_b32 v18, s68, 1
  s_add_u32 s68, s63, 1
  s_lshr_b32 s68, s68, 5
  s_lshl_b32 s68, s68, 9
  s_add_u32 s68, s68, s65
  s_add_u32 s68, s68, 4096
  v_writelane_b32 v18, s68, 2
  s_lshl_b32 s65, s64, 13
  s_lshl_b32 s68, s63, 2
  s_add_u32 s65, s65, s68
  s_add_u32 s65, s65, 24576
  v_lshlrev_b32 v28, 10, v0
  v_add_u32 v28, s65, v28
  v_mov_b32 v19, 0x40000000
  v_cmp_gt_u32 vcc, 8, v0
  s_nop 1
  v_cndmask_b32 v28, v19, v28, vcc
  s_branch fft_body
dft_end:
  s_mov_b32 s28, s16
  s_mov_b32 s29, s17
  s_mov_b32 s30, 1605632
  s_mov_b32 s31, 0x00020000
  v_mul_u32_u24 v8, 896, v1
  s_and_b32 s65, s60, 3
  s_mul_i32 s65, s65, 200704
  s_lshl_b32 s66, s3, 7
  s_add_u32 s65, s65, s66
  s_cmp_eq_u32 s3, 7
  s_cselect_b32 s65, 0x40000000, s65
  s_add_u32 s66, s3, 4
  s_cmp_ge_u32 s66, 7
  s_cselect_b32 s67, 7, 0
  s_sub_u32 s66, s66, s67
  s_mul_i32 s66, s66, 28672
  s_add_u32 s66, s66, s65
  s_add_u32 s66, s66, 0
  buffer_load_dword v16, v8, s[28:31], s66 offen
  s_add_u32 s66, s3, 5
  s_cmp_ge_u32 s66, 7
  s_cselect_b32 s67, 7, 0
  s_sub_u32 s66, s66, s67
  s_mul_i32 s66, s66, 28672
  s_add_u32 s66, s66, s65
  s_add_u32 s66, s66, 0
  buffer_load_dword v17, v8, s[28:31], s66 offen
  s_add_u32 s66, s3, 6
  s_cmp_ge_u32 s66, 7
  s_cselect_b32 s67, 7, 0
  s_sub_u32 s66, s66, s67
  s_mul_i32 s66, s66, 28672
  s_add_u32 s66, s66, s65
  s_add_u32 s66, s66, 0
  buffer_load_dword v18, v8, s[28:31], s66 offen
  s_add_u32 s66, s3, 2
  s_cmp_ge_u32 s66, 7
  s_cselect_b32 s67, 7, 0
  s_sub_u32 s66, s66, s67
  s_mul_i32 s66, s66, 28672
  s_add_u32 s66, s66, s65
  s_add_u32 s66, s66, 802816
  buffer_load_dword v19, v8, s[28:31], s66 offen
  s_add_u32 s66, s3, 3
  s_cmp_ge_u32 s66, 7
  s_cselect_b32 s67, 7, 0
  s_sub_u32 s66, s66, s67
  s_mul_i32 s66, s66, 28672
  s_add_u32 s66, s66, s65
  s_add_u32 s66, s66, 802816
  buffer_load_dword v20, v8, s[28:31], s66 offen
  s_add_u32 s66, s3, 4
  s_cmp_ge_u32 s66, 7
  s_cselect_b32 s67, 7, 0
  s_sub_u32 s66, s66, s67
  s_mul_i32 s66, s66, 28672
  s_add_u32 s66, s66, s65
  s_add_u32 s66, s66, 802816
  buffer_load_dword v21, v8, s[28:31], s66 offen
  s_add_u32 s66, s3, 5
  s_cmp_ge_u32 s66, 7
  s_cselect_b32 s67, 7, 0
  s_sub_u32 s66, s66, s67
  s_mul_i32 s66, s66, 28672
  s_add_u32 s66, s66, s65
  s_add_u32 s66, s66, 802816
  buffer_load_dword v22, v8, s[28:31], s66 offen
  s_add_u32 s66, s3, 6
  s_cmp_ge_u32 s66, 7
  s_cselect_b32 s67, 7, 0
  s_sub_u32 s66, s66, s67
  s_mul_i32 s66, s66, 28672
  s_add_u32 s66, s66, s65
  s_add_u32 s66, s66, 802816
  buffer_load_dword v23, v8, s[28:31], s66 offen
  s_waitcnt vmcnt(0)
  s_endpgm
l1_clr:
  s_add_u32 s48, s22, 13165312
  s_addc_u32 s49, s23, 0
  s_mov_b32 s50, 81920
  s_mov_b32 s51, 0x00020000
  v_lshlrev_b32 v24, 4, v0
  s_lshl_b32 s80, s60, 11
  s_add_u32 s67, s80, 2048
  s_mul_i32 s81, s60, 3072
  s_sub_u32 s81, s81, 8192
  s_cmp_lt_u32 s60, 8
  s_cselect_b32 s80, s80, s81
  s_cselect_b32 s50, s67, s50
  s_cselect_b32 s67, -1, 0
  v_mov_b32 v16, s67
  v_mov_b32 v17, s67
  v_mov_b32 v18, s67
  v_mov_b32 v19, s67
  buffer_store_dwordx4 v[16:19], v24, s[48:51], s80 offen offset:0 sc0 sc1
  buffer_store_dwordx4 v[16:19], v24, s[48:51], s80 offen offset:1024 sc0 sc1
  buffer_store_dwordx4 v[16:19], v24, s[48:51], s80 offen offset:2048 sc0 sc1
  s_branch l1_ret
dft_stat:
  s_add_u32 s52, s22, 13165312
  s_addc_u32 s53, s23, 0
  s_mov_b32 s54, 16384
  s_mov_b32 s55, 0x00020000
  s_mov_b32 s40, s20
  s_mov_b32 s41, s21
  s_mov_b32 s42, 256
  s_mov_b32 s43, 0x00020000
  s_add_u32 s36, s22, 13181696
  s_addc_u32 s37, s23, 0
  s_mov_b32 s38, 65536
  s_mov_b32 s39, 0x00020000
  v_lshlrev_b32 v4, 2, v0
  v_lshlrev_b32 v23, 20, v0
  v_mov_b32 v22, 1
  v_add_u32 v30, 155648, v4
  v_mov_b32 v31, 0
  ds_write_b32 v30, v31
  v_and_b32 v8, 15, v0
  v_lshrrev_b32 v9, 4, v0
  v_bfe_u32 v10, v0, 1, 3
  v_xor_b32 v10, v10, v9
  v_lshlrev_b32 v10, 4, v10
  v_lshl_add_u32 v10, v8, 7, v10
  v_xor_b32 v11, 64, v10
  v_mov_b32 v144, 0x3f803f80
  v_mov_b32 v145, 0x3f803f80
  v_mov_b32 v146, 0x3f803f80
  v_mov_b32 v147, 0x3f803f80
  v_lshlrev_b32 v8, 3, v8
  v_add_u32 v8, 122880, v8
  v_lshlrev_b32 v9, 3, v0
  v_add_u32 v9, 122880, v9
  v_and_b32 v13, 3, v0
  v_cmp_eq_u32 s[68:69], 1, v13
  v_cmp_eq_u32 s[86:87], 2, v13
  v_cmp_eq_u32 s[74:75], 3, v13
  s_mov_b32 s85, 0xffff0000
  s_waitcnt vmcnt(7)
  buffer_atomic_add v22, v23, s[40:43], 0 offen sc1
  s_waitcnt vmcnt(6)
  s_waitcnt lgkmcnt(0)
  ds_read_b128 v[96:99], v2 offset:0
  ds_read_b128 v[100:103], v6 offset:0
  s_waitcnt lgkmcnt(0)
  v_perm_b32 v104, v97, v96, s70
  v_perm_b32 v105, v99, v98, s70
  v_perm_b32 v106, v101, v100, s70
  v_perm_b32 v107, v103, v102, s70
  v_perm_b32 v108, v97, v96, s71
  v_perm_b32 v109, v99, v98, s71
  v_perm_b32 v110, v101, v100, s71
  v_perm_b32 v111, v103, v102, s71
  ds_write_b128 v2, v[104:107] offset:0
  ds_write_b128 v6, v[108:111] offset:0
  s_waitcnt lgkmcnt(0)
  s_barrier
  s_setprio 2
  ds_read_b128 v[32:35], v10 offset:0
  ds_read_b128 v[36:39], v10 offset:2048
  ds_read_b128 v[40:43], v10 offset:4096
  ds_read_b128 v[44:47], v10 offset:6144
  ds_read_b128 v[48:51], v11 offset:0
  ds_read_b128 v[52:55], v11 offset:2048
  ds_read_b128 v[56:59], v11 offset:4096
  ds_read_b128 v[60:63], v11 offset:6144
  s_waitcnt lgkmcnt(0)
  ds_read_b128 v[64:67], v10 offset:8192
  ds_read_b128 v[68:71], v10 offset:10240
  ds_read_b128 v[72:75], v10 offset:12288
  ds_read_b128 v[76:79], v10 offset:14336
  ds_read_b128 v[80:83], v11 offset:8192
  ds_read_b128 v[84:87], v11 offset:10240
  ds_read_b128 v[88:91], v11 offset:12288
  ds_read_b128 v[92:95], v11 offset:14336
  v_mfma_f32_16x16x32_bf16 v[160:163], v[32:35], v[32:35], 0
  v_mfma_f32_16x16x32_bf16 v[176:179], v[144:147], v[32:35], 0
  v_mfma_f32_16x16x32_bf16 v[164:167], v[36:39], v[36:39], 0
  v_mfma_f32_16x16x32_bf16 v[180:183], v[144:147], v[36:39], 0
  v_mfma_f32_16x16x32_bf16 v[168:171], v[40:43], v[40:43], 0
  v_mfma_f32_16x16x32_bf16 v[184:187], v[144:147], v[40:43], 0
  v_mfma_f32_16x16x32_bf16 v[172:175], v[44:47], v[44:47], 0
  v_mfma_f32_16x16x32_bf16 v[188:191], v[144:147], v[44:47], 0
  v_mfma_f32_16x16x32_bf16 v[160:163], v[48:51], v[48:51], v[160:163]
  v_mfma_f32_16x16x32_bf16 v[176:179], v[144:147], v[48:51], v[176:179]
  v_mfma_f32_16x16x32_bf16 v[164:167], v[52:55], v[52:55], v[164:167]
  v_mfma_f32_16x16x32_bf16 v[180:183], v[144:147], v[52:55], v[180:183]
  v_mfma_f32_16x16x32_bf16 v[168:171], v[56:59], v[56:59], v[168:171]
  v_mfma_f32_16x16x32_bf16 v[184:187], v[144:147], v[56:59], v[184:187]
  v_mfma_f32_16x16x32_bf16 v[172:175], v[60:63], v[60:63], v[172:175]
  v_mfma_f32_16x16x32_bf16 v[188:191], v[144:147], v[60:63], v[188:191]
  s_waitcnt lgkmcnt(0)
  s_waitcnt vmcnt(1)
  ds_read_b128 v[96:99], v2 offset:16384
  ds_read_b128 v[100:103], v6 offset:16384
  ds_read_b128 v[112:115], v2 offset:32768
  ds_read_b128 v[116:119], v6 offset:32768
  s_mov_b32 exec_hi, 0
  ds_read_b128 v[128:131], v2 offset:49152
  ds_read_b128 v[132:135], v6 offset:49152
  s_mov_b64 exec, -1
  s_waitcnt lgkmcnt(4)
  v_perm_b32 v104, v97, v96, s70
  v_perm_b32 v105, v99, v98, s70
  v_perm_b32 v106, v101, v100, s70
  v_perm_b32 v107, v103, v102, s70
  v_perm_b32 v108, v97, v96, s71
  v_perm_b32 v109, v99, v98, s71
  v_perm_b32 v110, v101, v100, s71
  v_perm_b32 v111, v103, v102, s71
  ds_write_b128 v2, v[104:107] offset:16384
  ds_write_b128 v6, v[108:111] offset:16384
  s_waitcnt lgkmcnt(4)
  v_perm_b32 v120, v113, v112, s70
  v_perm_b32 v121, v115, v114, s70
  v_perm_b32 v122, v117, v116, s70
  v_perm_b32 v123, v119, v118, s70
  v_perm_b32 v124, v113, v112, s71
  v_perm_b32 v125, v115, v114, s71
  v_perm_b32 v126, v117, v116, s71
  v_perm_b32 v127, v119, v118, s71
  ds_write_b128 v2, v[120:123] offset:32768
  ds_write_b128 v6, v[124:127] offset:32768
  s_waitcnt lgkmcnt(4)
  v_perm_b32 v136, v129, v128, s70
  v_perm_b32 v137, v131, v130, s70
  v_perm_b32 v138, v133, v132, s70
  v_perm_b32 v139, v135, v134, s70
  v_perm_b32 v140, v129, v128, s71
  v_perm_b32 v141, v131, v130, s71
  v_perm_b32 v142, v133, v132, s71
  v_perm_b32 v143, v135, v134, s71
  s_mov_b32 exec_hi, 0
  ds_write_b128 v2, v[136:139] offset:49152
  ds_write_b128 v6, v[140:143] offset:49152
  s_mov_b64 exec, -1
  s_waitcnt lgkmcnt(0)
  s_barrier
  buffer_load_dword v24, v23, s[40:43], 0 offen
  ds_read_b128 v[32:35], v10 offset:16384
  ds_read_b128 v[36:39], v10 offset:18432
  ds_read_b128 v[40:43], v10 offset:20480
  ds_read_b128 v[44:47], v10 offset:22528
  ds_read_b128 v[48:51], v11 offset:16384
  ds_read_b128 v[52:55], v11 offset:18432
  ds_read_b128 v[56:59], v11 offset:20480
  ds_read_b128 v[60:63], v11 offset:22528
  v_mfma_f32_16x16x32_bf16 v[160:163], v[64:67], v[64:67], v[160:163]
  v_mfma_f32_16x16x32_bf16 v[176:179], v[144:147], v[64:67], v[176:179]
  v_mfma_f32_16x16x32_bf16 v[164:167], v[68:71], v[68:71], v[164:167]
  v_mfma_f32_16x16x32_bf16 v[180:183], v[144:147], v[68:71], v[180:183]
  v_mfma_f32_16x16x32_bf16 v[168:171], v[72:75], v[72:75], v[168:171]
  v_mfma_f32_16x16x32_bf16 v[184:187], v[144:147], v[72:75], v[184:187]
  v_mfma_f32_16x16x32_bf16 v[172:175], v[76:79], v[76:79], v[172:175]
  v_mfma_f32_16x16x32_bf16 v[188:191], v[144:147], v[76:79], v[188:191]
  v_mfma_f32_16x16x32_bf16 v[160:163], v[80:83], v[80:83], v[160:163]
  v_mfma_f32_16x16x32_bf16 v[176:179], v[144:147], v[80:83], v[176:179]
  v_mfma_f32_16x16x32_bf16 v[164:167], v[84:87], v[84:87], v[164:167]
  v_mfma_f32_16x16x32_bf16 v[180:183], v[144:147], v[84:87], v[180:183]
  v_mfma_f32_16x16x32_bf16 v[168:171], v[88:91], v[88:91], v[168:171]
  v_mfma_f32_16x16x32_bf16 v[184:187], v[144:147], v[88:91], v[184:187]
  v_mfma_f32_16x16x32_bf16 v[172:175], v[92:95], v[92:95], v[172:175]
  v_mfma_f32_16x16x32_bf16 v[188:191], v[144:147], v[92:95], v[188:191]
  s_waitcnt lgkmcnt(0)
  ds_read_b128 v[64:67], v10 offset:24576
  ds_read_b128 v[68:71], v10 offset:26624
  ds_read_b128 v[72:75], v10 offset:28672
  ds_read_b128 v[76:79], v10 offset:30720
  ds_read_b128 v[80:83], v11 offset:24576
  ds_read_b128 v[84:87], v11 offset:26624
  ds_read_b128 v[88:91], v11 offset:28672
  ds_read_b128 v[92:95], v11 offset:30720
  v_mfma_f32_16x16x32_bf16 v[160:163], v[32:35], v[32:35], v[160:163]
  v_mfma_f32_16x16x32_bf16 v[176:179], v[144:147], v[32:35], v[176:179]
  v_mfma_f32_16x16x32_bf16 v[164:167], v[36:39], v[36:39], v[164:167]
  v_mfma_f32_16x16x32_bf16 v[180:183], v[144:147], v[36:39], v[180:183]
  v_mfma_f32_16x16x32_bf16 v[168:171], v[40:43], v[40:43], v[168:171]
  v_mfma_f32_16x16x32_bf16 v[184:187], v[144:147], v[40:43], v[184:187]
  v_mfma_f32_16x16x32_bf16 v[172:175], v[44:47], v[44:47], v[172:175]
  v_mfma_f32_16x16x32_bf16 v[188:191], v[144:147], v[44:47], v[188:191]
  v_mfma_f32_16x16x32_bf16 v[160:163], v[48:51], v[48:51], v[160:163]
  v_mfma_f32_16x16x32_bf16 v[176:179], v[144:147], v[48:51], v[176:179]
  v_mfma_f32_16x16x32_bf16 v[164:167], v[52:55], v[52:55], v[164:167]
  v_mfma_f32_16x16x32_bf16 v[180:183], v[144:147], v[52:55], v[180:183]
  v_mfma_f32_16x16x32_bf16 v[168:171], v[56:59], v[56:59], v[168:171]
  v_mfma_f32_16x16x32_bf16 v[184:187], v[144:147], v[56:59], v[184:187]
  v_mfma_f32_16x16x32_bf16 v[172:175], v[60:63], v[60:63], v[172:175]
  v_mfma_f32_16x16x32_bf16 v[188:191], v[144:147], v[60:63], v[188:191]
  s_waitcnt lgkmcnt(0)
  ds_read_b128 v[32:35], v10 offset:32768
  ds_read_b128 v[36:39], v10 offset:34816
  ds_read_b128 v[40:43], v10 offset:36864
  ds_read_b128 v[44:47], v10 offset:38912
  ds_read_b128 v[48:51], v11 offset:32768
  ds_read_b128 v[52:55], v11 offset:34816
  ds_read_b128 v[56:59], v11 offset:36864
  ds_read_b128 v[60:63], v11 offset:38912
  v_mfma_f32_16x16x32_bf16 v[160:163], v[64:67], v[64:67], v[160:163]
  v_mfma_f32_16x16x32_bf16 v[176:179], v[144:147], v[64:67], v[176:179]
  v_mfma_f32_16x16x32_bf16 v[164:167], v[68:71], v[68:71], v[164:167]
  v_mfma_f32_16x16x32_bf16 v[180:183], v[144:147], v[68:71], v[180:183]
  v_mfma_f32_16x16x32_bf16 v[168:171], v[72:75], v[72:75], v[168:171]
  v_mfma_f32_16x16x32_bf16 v[184:187], v[144:147], v[72:75], v[184:187]
  v_mfma_f32_16x16x32_bf16 v[172:175], v[76:79], v[76:79], v[172:175]
  v_mfma_f32_16x16x32_bf16 v[188:191], v[144:147], v[76:79], v[188:191]
  v_mfma_f32_16x16x32_bf16 v[160:163], v[80:83], v[80:83], v[160:163]
  v_mfma_f32_16x16x32_bf16 v[176:179], v[144:147], v[80:83], v[176:179]
  v_mfma_f32_16x16x32_bf16 v[164:167], v[84:87], v[84:87], v[164:167]
  v_mfma_f32_16x16x32_bf16 v[180:183], v[144:147], v[84:87], v[180:183]
  v_mfma_f32_16x16x32_bf16 v[168:171], v[88:91], v[88:91], v[168:171]
  v_mfma_f32_16x16x32_bf16 v[184:187], v[144:147], v[88:91], v[184:187]
  v_mfma_f32_16x16x32_bf16 v[172:175], v[92:95], v[92:95], v[172:175]
  v_mfma_f32_16x16x32_bf16 v[188:191], v[144:147], v[92:95], v[188:191]
  s_waitcnt lgkmcnt(0)
  ds_read_b128 v[64:67], v10 offset:40960
  ds_read_b128 v[68:71], v10 offset:43008
  ds_read_b128 v[72:75], v10 offset:45056
  ds_read_b128 v[76:79], v10 offset:47104
  ds_read_b128 v[80:83], v11 offset:40960
  ds_read_b128 v[84:87], v11 offset:43008
  ds_read_b128 v[88:91], v11 offset:45056
  ds_read_b128 v[92:95], v11 offset:47104
  v_mfma_f32_16x16x32_bf16 v[160:163], v[32:35], v[32:35], v[160:163]
  v_mfma_f32_16x16x32_bf16 v[176:179], v[144:147], v[32:35], v[176:179]
  v_mfma_f32_16x16x32_bf16 v[164:167], v[36:39], v[36:39], v[164:167]
  v_mfma_f32_16x16x32_bf16 v[180:183], v[144:147], v[36:39], v[180:183]
  v_mfma_f32_16x16x32_bf16 v[168:171], v[40:43], v[40:43], v[168:171]
  v_mfma_f32_16x16x32_bf16 v[184:187], v[144:147], v[40:43], v[184:187]
  v_mfma_f32_16x16x32_bf16 v[172:175], v[44:47], v[44:47], v[172:175]
  v_mfma_f32_16x16x32_bf16 v[188:191], v[144:147], v[44:47], v[188:191]
  v_mfma_f32_16x16x32_bf16 v[160:163], v[48:51], v[48:51], v[160:163]
  v_mfma_f32_16x16x32_bf16 v[176:179], v[144:147], v[48:51], v[176:179]
  v_mfma_f32_16x16x32_bf16 v[164:167], v[52:55], v[52:55], v[164:167]
  v_mfma_f32_16x16x32_bf16 v[180:183], v[144:147], v[52:55], v[180:183]
  v_mfma_f32_16x16x32_bf16 v[168:171], v[56:59], v[56:59], v[168:171]
  v_mfma_f32_16x16x32_bf16 v[184:187], v[144:147], v[56:59], v[184:187]
  v_mfma_f32_16x16x32_bf16 v[172:175], v[60:63], v[60:63], v[172:175]
  v_mfma_f32_16x16x32_bf16 v[188:191], v[144:147], v[60:63], v[188:191]
  s_waitcnt lgkmcnt(0)
  ds_read_b128 v[32:35], v10 offset:49152
  ds_read_b128 v[36:39], v10 offset:51200
  ds_read_b128 v[40:43], v10 offset:53248
  ds_read_b128 v[44:47], v10 offset:55296
  ds_read_b128 v[48:51], v11 offset:49152
  ds_read_b128 v[52:55], v11 offset:51200
  ds_read_b128 v[56:59], v11 offset:53248
  ds_read_b128 v[60:63], v11 offset:55296
  v_mfma_f32_16x16x32_bf16 v[160:163], v[64:67], v[64:67], v[160:163]
  v_mfma_f32_16x16x32_bf16 v[176:179], v[144:147], v[64:67], v[176:179]
  v_mfma_f32_16x16x32_bf16 v[164:167], v[68:71], v[68:71], v[164:167]
  v_mfma_f32_16x16x32_bf16 v[180:183], v[144:147], v[68:71], v[180:183]
  v_mfma_f32_16x16x32_bf16 v[168:171], v[72:75], v[72:75], v[168:171]
  v_mfma_f32_16x16x32_bf16 v[184:187], v[144:147], v[72:75], v[184:187]
  v_mfma_f32_16x16x32_bf16 v[172:175], v[76:79], v[76:79], v[172:175]
  v_mfma_f32_16x16x32_bf16 v[188:191], v[144:147], v[76:79], v[188:191]
  v_mfma_f32_16x16x32_bf16 v[160:163], v[80:83], v[80:83], v[160:163]
  v_mfma_f32_16x16x32_bf16 v[176:179], v[144:147], v[80:83], v[176:179]
  v_mfma_f32_16x16x32_bf16 v[164:167], v[84:87], v[84:87], v[164:167]
  v_mfma_f32_16x16x32_bf16 v[180:183], v[144:147], v[84:87], v[180:183]
  v_mfma_f32_16x16x32_bf16 v[168:171], v[88:91], v[88:91], v[168:171]
  v_mfma_f32_16x16x32_bf16 v[184:187], v[144:147], v[88:91], v[184:187]
  v_mfma_f32_16x16x32_bf16 v[172:175], v[92:95], v[92:95], v[172:175]
  v_mfma_f32_16x16x32_bf16 v[188:191], v[144:147], v[92:95], v[188:191]
  s_waitcnt lgkmcnt(0)
  v_mfma_f32_16x16x32_bf16 v[160:163], v[32:35], v[32:35], v[160:163]
  v_mfma_f32_16x16x32_bf16 v[176:179], v[144:147], v[32:35], v[176:179]
  v_mfma_f32_16x16x32_bf16 v[164:167], v[36:39], v[36:39], v[164:167]
  v_mfma_f32_16x16x32_bf16 v[180:183], v[144:147], v[36:39], v[180:183]
  v_mfma_f32_16x16x32_bf16 v[168:171], v[40:43], v[40:43], v[168:171]
  v_mfma_f32_16x16x32_bf16 v[184:187], v[144:147], v[40:43], v[184:187]
  v_mfma_f32_16x16x32_bf16 v[172:175], v[44:47], v[44:47], v[172:175]
  v_mfma_f32_16x16x32_bf16 v[188:191], v[144:147], v[44:47], v[188:191]
  v_mfma_f32_16x16x32_bf16 v[160:163], v[48:51], v[48:51], v[160:163]
  v_mfma_f32_16x16x32_bf16 v[176:179], v[144:147], v[48:51], v[176:179]
  v_mfma_f32_16x16x32_bf16 v[164:167], v[52:55], v[52:55], v[164:167]
  v_mfma_f32_16x16x32_bf16 v[180:183], v[144:147], v[52:55], v[180:183]
  v_mfma_f32_16x16x32_bf16 v[168:171], v[56:59], v[56:59], v[168:171]
  v_mfma_f32_16x16x32_bf16 v[184:187], v[144:147], v[56:59], v[184:187]
  v_mfma_f32_16x16x32_bf16 v[172:175], v[60:63], v[60:63], v[172:175]
  v_mfma_f32_16x16x32_bf16 v[188:191], v[144:147], v[60:63], v[188:191]
  s_nop 1
  v_cndmask_b32 v177, v160, v161, s[68:69]
  v_cndmask_b32 v177, v177, v162, s[86:87]
  v_cndmask_b32 v177, v177, v163, s[74:75]
  v_cndmask_b32 v181, v164, v165, s[68:69]
  v_cndmask_b32 v181, v181, v166, s[86:87]
  v_cndmask_b32 v181, v181, v167, s[74:75]
  v_cndmask_b32 v185, v168, v169, s[68:69]
  v_cndmask_b32 v185, v185, v170, s[86:87]
  v_cndmask_b32 v185, v185, v171, s[74:75]
  v_cndmask_b32 v189, v172, v173, s[68:69]
  v_cndmask_b32 v189, v189, v174, s[86:87]
  v_cndmask_b32 v189, v189, v175, s[74:75]
  s_mov_b32 exec_lo, 0x00f0000f
  s_mov_b32 exec_hi, 0xf0000f00
  ds_write_b64 v8, v[176:177] offset:0
  ds_write_b64 v8, v[180:181] offset:128
  ds_write_b64 v8, v[184:185] offset:256
  ds_write_b64 v8, v[188:189] offset:384
  s_mov_b64 exec, -1
  s_mov_b32 s84, 0x3b124925
  s_waitcnt lgkmcnt(0)
  ds_read_b64 v[16:17], v9
  s_waitcnt lgkmcnt(0)
  v_mul_f32 v16, s84, v16
  v_mul_f32 v18, v16, v16
  v_fma_f32 v17, v17, s84, -v18
  v_max_f32 v17, 0, v17
  v_cvt_pk_bf16_f32 v18, v16, v17
  v_lshlrev_b32 v16, 16, v18
  v_cvt_pk_bf16_f32 v20, -v16, -v16
  v_and_b32 v17, s85, v18
  v_add_f32 v17, 0x3727c5ac, v17
  v_cvt_pk_bf16_f32 v17, v17, v17
  v_and_b32 v17, s85, v17
  v_sqrt_f32 v17, v17
  s_nop 0
  v_cvt_pk_bf16_f32 v17, v17, v17
  v_and_b32 v17, s85, v17
  v_rcp_f32 v17, v17
  s_nop 0
  v_mul_f32 v16, v16, v17
  v_mul_f32 v21, v17, v17
  v_mov_b32 v18, v17
  v_mul_f32 v19, 0x43e00000, v16
  s_add_u32 s84, s83, 8192
  ds_write_b64 v9, v[18:19] offset:512
  v_mov_b32 v30, 155776
  s_waitcnt lgkmcnt(0)
  ds_write_b32 v30, v22
  s_waitcnt vmcnt(0)
  s_mov_b32 s77, 20000
dfs_l1:
  v_readfirstlane_b32 s80, v24
  s_cmp_eq_u32 s80, 32
  s_cbranch_scc1 dfs_l1ok
  s_sub_u32 s77, s77, 1
  s_cbranch_scc1 dfs_l1ok
  s_sleep 8
  buffer_load_dword v24, v23, s[40:43], 0 offen sc1
  s_waitcnt vmcnt(0)
  s_branch dfs_l1
dfs_l1ok:
  buffer_store_dword v20, v4, s[52:55], s83 offen sc0 sc1
  buffer_store_dword v21, v4, s[52:55], s84 offen sc0 sc1
  s_setprio 0
  v_lshlrev_b32 v14, 7, v0
  s_lshl_b32 s67, s60, 2
  s_waitcnt vmcnt(0)
  s_barrier
  buffer_atomic_add v22, v14, s[36:39], 0 offen sc1
  s_branch dft_tail
f_end:
  s_endpgm
.section .rodata,"a"
.p2align 6
.amdhsa_kernel parallel_sum__spectral_gfnet__glu_gated_reglu__prompt_kernel
  .amdhsa_next_free_vgpr 256
  .amdhsa_next_free_sgpr 102
  .amdhsa_accum_offset 256
  .amdhsa_group_segment_fixed_size 0
  .amdhsa_kernarg_size 80
  .amdhsa_user_sgpr_count 2
  .amdhsa_user_sgpr_kernarg_segment_ptr 1
  .amdhsa_system_sgpr_workgroup_id_x 1
.end_amdhsa_kernel
```
